```python
import torch

def _softmax(x, axis=-1):
    return torch.softmax(x, dim=axis)
def _gelu(x):
    return torch.nn.functional.gelu(x, approximate="tanh")
def _silu(x):
    return torch.nn.functional.silu(x)
def _sigmoid(x):
    return torch.sigmoid(x)
def _layernorm(x, axis=-1, eps=1e-5):
    m = x.mean(dim=axis, keepdim=True)
    v = x.var(dim=axis, keepdim=True, unbiased=False)
    return (x - m) / torch.sqrt(v + eps)
def _scatter_add(tgt, idx, src, axis=0):
    return tgt.clone().index_add_(axis, idx, src)
def _segment_sum(src, seg, n):
    out = torch.zeros((n,) + src.shape[1:], dtype=src.dtype)
    return out.index_add_(0, seg, src)
def _pad(x, pw):
    flat = tuple(v for pair in reversed(pw) for v in pair)
    return torch.nn.functional.pad(x, flat)

kernel_name = 'standalone__mixer_s_mlp__sampling'

def setup_inputs():

    _w = (lambda a: (lambda t: t.to(torch.bfloat16) if t.is_floating_point() else t)(torch.as_tensor(a)))
    B, S, D, F = 32, 32, 576, 4608
    return {
        "x":  _w((lambda *s: torch.randn(*s, dtype=torch.bfloat16) * 0.4)(B, S, D)),
        "w1": _w((lambda *s: torch.randn(*s, dtype=torch.bfloat16) * 3.2)(D, D) * (D ** -0.5)),
        "w2": _w((lambda *s: torch.randn(*s, dtype=torch.bfloat16) * 3.2)(D, D) * (D ** -0.5)),
        "w3": _w((lambda *s: torch.randn(*s, dtype=torch.bfloat16) * 3.2)(D, F) * (D ** -0.5)),
        "w4": _w((lambda *s: torch.randn(*s, dtype=torch.bfloat16) * 0.8)(F, D) * (F ** -0.5)),
    }

def reference(x, w1, w2, w3, w4):
    B, S, D = x.shape
    h = _gelu(_layernorm(x, axis=-1) @ w1)
    c = D // 4
    g0 = _pad(h[:, :, 0*c:1*c], ((0, 0), (1, 0), (0, 0)))[:, :S, :]
    g1 = _pad(h[:, :, 1*c:2*c], ((0, 0), (0, 1), (0, 0)))[:, 1:, :]
    g2 = _pad(h[:, :, 2*c:3*c], ((0, 0), (2, 0), (0, 0)))[:, :S, :]
    g3 = _pad(h[:, :, 3*c:   ], ((0, 0), (0, 2), (0, 0)))[:, 2:, :]
    hs = torch.concatenate([g0, g1, g2, g3], axis=-1) @ w2
    x1 = x + hs
    h2 = _gelu(_layernorm(x1, axis=-1) @ w3) @ w4
    return x1 + h2
```

```asm
; @launch grid=(256,1,1) block=(256,1,1) lds=163840
.amdgcn_target "amdgcn-amd-amdhsa--gfx950"
.text
.globl standalone__mixer_s_mlp__sampling_kernel
.p2align 8
.type standalone__mixer_s_mlp__sampling_kernel,@function
standalone__mixer_s_mlp__sampling_kernel:

    s_cmp_ge_u32 s2, 256
    s_cbranch_scc1 L_end
    s_load_dwordx16 s[16:31], s[0:1], 0
    s_memrealtime s[10:11]
    s_getpc_b64 s[98:99]
    v_lshrrev_b32 v1, 6, v0
    v_and_b32 v0, 63, v0
    s_and_b32 s4, s2, 7
    v_readfirstlane_b32 s3, v1
    s_lshr_b32 s5, s2, 3
    s_cmp_lg_u32 s5, 31
    s_cbranch_scc1 L_nopf
    v_lshlrev_b32 v29, 7, v0
    s_lshl_b32 s12, s3, 13
    v_add_u32 v29, s12, v29
    v_add_u32 v30, 0x8000, v29
    v_min_u32 v29, 0x9028, v29
    v_min_u32 v30, 0x9028, v30
    global_load_dword v251, v29, s[98:99]
    global_load_dword v250, v30, s[98:99]
L_nopf:
    s_lshl_b32 s6, s4, 1
    s_sub_u32 s7, s5, 14
    s_cmp_ge_u32 s5, 18
    s_cselect_b32 s7, s7, s5
    s_cmp_ge_u32 s7, 9
    s_cselect_b32 s12, 1, 0
    s_cselect_b32 s13, 9, 0
    s_add_u32 s6, s6, s12
    s_sub_u32 s7, s7, s13
    s_lshl_b32 s12, s6, 6
    s_lshl_b32 s13, s3, 4
    s_add_u32 s12, s12, s13
    s_mul_i32 s15, s12, 1152
    s_lshl_b32 s100, s7, 7
    s_cmp_lt_u32 s5, 18
    s_cbranch_scc1 L_apro
    s_sub_u32 s14, s5, 18
    s_lshl_b32 s14, s14, 2
    s_add_u32 s14, s14, s3
    s_mul_i32 s12, s4, 648
    s_mul_i32 s13, s14, 93
    s_add_u32 s12, s12, s13
    v_min_u32 v229, 46, v0
    v_add_u32 v230, s13, v229
    v_add_u32 v31, s12, v229
    v_subrev_u32 v218, 5184, v31
    v_min_u32 v218, v218, v31
    v_lshlrev_b32 v218, 7, v218
    v_add_u32 v31, 47, v31
    v_subrev_u32 v219, 5184, v31
    v_min_u32 v219, v219, v31
    v_lshlrev_b32 v219, 7, v219
    s_mul_i32 s12, s4, 56
    s_add_u32 s12, s12, s14
    s_mul_i32 s13, s12, 21
    v_min_u32 v220, 20, v0
    v_add_u32 v220, s13, v220
    v_lshlrev_b32 v220, 7, v220
    s_mul_i32 s13, s12, 12
    v_min_u32 v221, 11, v0
    v_add_u32 v221, s13, v221
    v_min_u32 v221, 5183, v221
    v_lshlrev_b32 v221, 7, v221
    s_waitcnt lgkmcnt(0)
    s_add_u32 s30, s30, 0
    s_addc_u32 s31, s31, 0
    global_load_dword v208, v218, s[18:19]
    global_load_dword v209, v219, s[18:19]
    s_waitcnt vmcnt(0)
    global_load_dword v238, v220, s[30:31]
    global_load_dword v239, v218, s[20:21]
    global_load_dword v237, v219, s[20:21]
    s_mul_i32 s13, s4, 1152

    v_add_u32 v30, 0, v230
    v_min_u32 v30, 5183, v30
    v_mul_u32_u24 v31, 7282, v30
    v_lshrrev_b32 v31, 16, v31
    v_mul_u32_u24 v228, 8064, v31
    v_lshl_add_u32 v30, v30, 7, v228
    v_add_u32 v224, s13, v30

    v_add_u32 v30, 47, v230
    v_min_u32 v30, 5183, v30
    v_mul_u32_u24 v31, 7282, v30
    v_lshrrev_b32 v31, 16, v31
    v_mul_u32_u24 v228, 8064, v31
    v_lshl_add_u32 v30, v30, 7, v228
    v_add_u32 v225, s13, v30

    s_mov_b32 s32, s16
    s_and_b32 s33, s17, 0xffff
    s_mov_b32 s34, 1179648
    s_mov_b32 s35, 0x20000

    v_mov_b32 v4, 0
    s_branch L_skipx
L_apro:
    v_mov_b32 v224, 0
    v_mov_b32 v225, 0
    v_lshrrev_b32 v29, 3, v0
    v_lshrrev_b32 v30, 1, v29
    v_and_b32 v31, 7, v0
    v_xor_b32 v30, v30, v31
    v_mul_u32_u24 v208, 1152, v29
    v_lshl_add_u32 v208, v30, 4, v208
    v_xor_b32 v209, 64, v208
    v_add_u32 v209, 8192, v209
    s_mul_i32 s14, s3, 18432
    s_add_u32 s14, s14, 73728
    s_lshl_b32 s12, s7, 11
    s_add_u32 m0, s12, s14
    s_add_u32 s13, s100, s15
    s_add_u32 s101, s15, 1152

    s_waitcnt lgkmcnt(0)
    s_mov_b32 s32, s16
    s_and_b32 s33, s17, 0xffff
    s_mov_b32 s34, 1179648
    s_mov_b32 s35, 0x20000

    s_add_u32 s30, s30, 0
    s_addc_u32 s31, s31, 0
    buffer_load_dwordx4 v208, s[32:35], s13 offen lds
    buffer_load_dwordx4 v209, s[32:35], s13 offen offset:1024 lds

    s_add_u32 m0, m0, 2048
    s_add_u32 s13, s13, 128
    s_cmp_eq_u32 s13, s101
    s_cselect_b32 m0, s14, m0
    s_cselect_b32 s13, s15, s13

    buffer_load_dwordx4 v208, s[32:35], s13 offen lds
    buffer_load_dwordx4 v209, s[32:35], s13 offen offset:1024 lds

    s_add_u32 m0, m0, 2048
    s_add_u32 s13, s13, 128
    s_cmp_eq_u32 s13, s101
    s_cselect_b32 m0, s14, m0
    s_cselect_b32 s13, s15, s13

    buffer_load_dwordx4 v208, s[32:35], s13 offen lds
    buffer_load_dwordx4 v209, s[32:35], s13 offen offset:1024 lds

    s_add_u32 m0, m0, 2048
    s_add_u32 s13, s13, 128
    s_cmp_eq_u32 s13, s101
    s_cselect_b32 m0, s14, m0
    s_cselect_b32 s13, s15, s13

    buffer_load_dwordx4 v208, s[32:35], s13 offen lds
    buffer_load_dwordx4 v209, s[32:35], s13 offen offset:1024 lds

    s_add_u32 m0, m0, 2048
    s_add_u32 s13, s13, 128
    s_cmp_eq_u32 s13, s101
    s_cselect_b32 m0, s14, m0
    s_cselect_b32 s13, s15, s13

    buffer_load_dwordx4 v208, s[32:35], s13 offen lds
    buffer_load_dwordx4 v209, s[32:35], s13 offen offset:1024 lds

    s_add_u32 m0, m0, 2048
    s_add_u32 s13, s13, 128
    s_cmp_eq_u32 s13, s101
    s_cselect_b32 m0, s14, m0
    s_cselect_b32 s13, s15, s13

    buffer_load_dwordx4 v208, s[32:35], s13 offen lds
    buffer_load_dwordx4 v209, s[32:35], s13 offen offset:1024 lds

    s_add_u32 m0, m0, 2048
    s_add_u32 s13, s13, 128
    s_cmp_eq_u32 s13, s101
    s_cselect_b32 m0, s14, m0
    s_cselect_b32 s13, s15, s13

    buffer_load_dwordx4 v208, s[32:35], s13 offen lds
    buffer_load_dwordx4 v209, s[32:35], s13 offen offset:1024 lds

    s_add_u32 m0, m0, 2048
    s_add_u32 s13, s13, 128
    s_cmp_eq_u32 s13, s101
    s_cselect_b32 m0, s14, m0
    s_cselect_b32 s13, s15, s13

    buffer_load_dwordx4 v208, s[32:35], s13 offen lds
    buffer_load_dwordx4 v209, s[32:35], s13 offen offset:1024 lds

    s_add_u32 m0, m0, 2048
    s_add_u32 s13, s13, 128
    s_cmp_eq_u32 s13, s101
    s_cselect_b32 m0, s14, m0
    s_cselect_b32 s13, s15, s13

    buffer_load_dwordx4 v208, s[32:35], s13 offen lds
    buffer_load_dwordx4 v209, s[32:35], s13 offen offset:1024 lds

    v_lshrrev_b32 v29, 3, v0
    v_and_b32 v30, 6, v29
    v_and_b32 v31, 7, v0
    v_xor_b32 v30, v30, v31
    v_lshlrev_b32 v30, 2, v30
    v_mov_b32 v31, 0x75643120
    v_lshrrev_b32 v30, v30, v31
    v_and_b32 v30, 7, v30

    v_and_b32 v31, 4, v29
    v_add_u32 v29, v29, v31
    v_mul_u32_u24 v4, 1152, v29
    v_lshl_add_u32 v4, v30, 4, v4
L_skipx:
    s_mov_b32 s36, s18
    s_and_b32 s37, s19, 0xffff
    s_mov_b32 s38, 663552
    s_mov_b32 s39, 0x20000

    s_mov_b32 s40, s20
    s_and_b32 s41, s21, 0xffff
    s_mov_b32 s42, 663552
    s_mov_b32 s43, 0x20000

    s_mov_b32 s44, s22
    s_and_b32 s45, s23, 0xffff
    s_mov_b32 s46, 5308416
    s_mov_b32 s47, 0x20000

    s_mov_b32 s48, s24
    s_and_b32 s49, s25, 0xffff
    s_mov_b32 s50, 5308416
    s_mov_b32 s51, 0x20000

    s_mov_b32 s52, s30
    s_and_b32 s53, s31, 0xffff
    s_mov_b32 s54, 32636928
    s_mov_b32 s55, 0x20000

    s_mov_b32 s56, s26
    s_and_b32 s57, s27, 0xffff
    s_mov_b32 s58, 1179648
    s_mov_b32 s59, 0x20000

    s_mov_b32 s60, s28
    s_and_b32 s61, s29, 0xffff
    s_mov_b32 s62, 256
    s_mov_b32 s63, 0x20000

    s_cmp_ge_u32 s5, 18
    s_cbranch_scc1 L_skipw1
    s_mul_i32 s12, s3, 18
    s_mul_i32 s20, s12, 9216
    s_add_u32 s20, s20, s100
    s_lshl_b32 s12, s12, 10
    s_add_u32 m0, s12, 0
    s_nop 0
    buffer_load_dwordx4 v4, s[36:39], s20 offen lds
    s_add_u32 m0, m0, 1024
    s_add_u32 s20, s20, 4608
    buffer_load_dwordx4 v4, s[36:39], s20 offen lds
    s_add_u32 m0, m0, 1024
    s_add_u32 s20, s20, 13824
    buffer_load_dwordx4 v4, s[36:39], s20 offen lds
    s_add_u32 m0, m0, 1024
    s_add_u32 s20, s20, 4608
    buffer_load_dwordx4 v4, s[36:39], s20 offen lds
    s_add_u32 m0, m0, 1024
    s_add_u32 s20, s20, 13824
    buffer_load_dwordx4 v4, s[36:39], s20 offen lds
    s_add_u32 m0, m0, 1024
    s_add_u32 s20, s20, 4608
    buffer_load_dwordx4 v4, s[36:39], s20 offen lds
    s_add_u32 m0, m0, 1024
    s_add_u32 s20, s20, 13824
    buffer_load_dwordx4 v4, s[36:39], s20 offen lds
    s_add_u32 m0, m0, 1024
    s_add_u32 s20, s20, 4608
    buffer_load_dwordx4 v4, s[36:39], s20 offen lds
    s_add_u32 m0, m0, 1024
    s_add_u32 s20, s20, 13824
    buffer_load_dwordx4 v4, s[36:39], s20 offen lds
    s_add_u32 m0, m0, 1024
    s_add_u32 s20, s20, 4608
    buffer_load_dwordx4 v4, s[36:39], s20 offen lds
L_skipw1:
    v_lshrrev_b32 v1, 4, v0
    v_and_b32 v2, 15, v0
    v_mov_b32 v3, 0
    v_lshlrev_b32 v10, 4, v0
    v_mov_b32 v18, 0x3f803f80
    v_cmp_eq_u32 vcc, 0, v0
    v_mov_b32 v19, 0x7ff00000
    s_and_b32 s8, s5, 3
    s_lshr_b32 s9, s5, 2

    v_cndmask_b32 v19, v19, v3, vcc
    s_cmp_lg_u32 s2, 248
    s_cbranch_scc1 L_nononce
    s_cmp_lg_u32 s3, 0
    s_cbranch_scc1 L_nononce
    s_or_b32 s11, s11, 0x40000000
    v_mov_b32 v24, s10
    v_mov_b32 v25, s11
    buffer_store_dwordx2 v[24:25], v19, s[60:63], 0 offen sc1
L_nononce:
    v_lshrrev_b32 v29, 5, v0
    v_lshlrev_b32 v29, 4, v29
    v_bfe_u32 v30, v0, 4, 1
    v_lshl_add_u32 v29, v30, 2, v29
    v_bfe_u32 v30, v0, 2, 2
    v_add_u32 v29, v29, v30
    v_and_b32 v30, 3, v0
    v_lshlrev_b32 v30, 3, v30
    v_and_b32 v26, 7, v29
    v_mul_u32_u24 v26, 1056, v26
    v_lshrrev_b32 v27, 3, v29
    v_lshl_add_u32 v26, v27, 8, v26
    v_add_u32 v26, v26, v30
    v_add_u32 v27, 0x10000, v26
    v_add_u32 v28, 0x20000, v26
    v_lshl_add_u32 v13, v29, 5, v30
    v_add_u32 v13, 147456, v13
    v_lshl_add_u32 v6, v29, 7, v30
    v_bfe_u32 v31, v29, 1, 2
    v_lshl_add_u32 v6, v31, 5, v6
    v_xor_b32 v7, 32, v6
    v_xor_b32 v8, 64, v6
    v_xor_b32 v9, 96, v6
    s_lshl_b32 s16, s4, 2
    s_add_u32 s16, s16, s8
    s_mul_i32 s17, s4, 1152
    s_lshl_b32 s12, s8, 5
    s_add_u32 s12, s12, s17
    s_add_u32 s12, s12, 1024
    s_lshl_b32 s13, s8, 8
    s_add_u32 s17, s17, s13
    s_mul_i32 s18, s8, 9
    s_lshr_b32 s18, s18, 1

    v_lshrrev_b32 v29, 1, v0
    v_mul_u32_u24 v5, 9216, v29
    v_and_b32 v29, 1, v0
    v_lshl_add_u32 v5, v29, 4, v5
    v_add_u32 v5, s12, v5
    s_add_u32 s25, s17, 128
    s_and_b32 s30, s9, 3
    s_lshl_b32 s30, s30, 2
    s_cmp_ge_u32 s5, 18
    s_cbranch_scc1 L_idle

    v_lshrrev_b32 v29, 1, v2
    v_xor_b32 v30, v29, v1
    v_lshlrev_b32 v210, 7, v2
    v_add_u32 v210, s14, v210
    v_and_b32 v31, 2, v1
    v_xor_b32 v31, v31, v29
    v_lshl_add_u32 v212, v31, 4, v210
    v_and_b32 v31, 1, v1
    v_lshl_add_u32 v212, v31, 3, v212
    s_lshl_b32 s12, s7, 11
    v_add_u32 v212, s12, v212
    v_xor_b32 v213, 16, v212
    v_xor_b32 v214, 64, v212
    v_xor_b32 v215, 80, v212
    v_lshl_add_u32 v210, v30, 4, v210
    v_xor_b32 v211, 64, v210
    s_lshl_b32 s26, s7, 1
    v_mov_b32 v216, v18
    v_mov_b32 v217, v18
    v_mov_b32 v218, v18
    v_mov_b32 v219, v18
    s_waitcnt vmcnt(10)
    ds_read_b128 a[0:3], v210 offset:0
    ds_read_b128 a[4:7], v211 offset:0
    ds_read_b128 a[8:11], v210 offset:2048
    ds_read_b128 a[12:15], v211 offset:2048
    ds_read_b128 a[16:19], v210 offset:4096
    ds_read_b128 a[20:23], v211 offset:4096
    ds_read_b128 a[24:27], v210 offset:6144
    ds_read_b128 a[28:31], v211 offset:6144
    s_waitcnt lgkmcnt(7)
    v_mfma_f32_16x16x32_bf16 v[152:155], v[216:219], a[0:3], 0
    ds_read_b128 a[32:35], v210 offset:8192
    s_add_u32 m0, m0, 1024
    s_add_u32 s20, s20, 13824
    buffer_load_dwordx4 v4, s[36:39], s20 offen lds
    s_lshl_b32 s12, s6, 2
    s_and_b32 s13, s3, 2
    v_mfma_f32_16x16x32_bf16 v[156:159], a[0:3], a[0:3], 0
    s_waitcnt lgkmcnt(6)
    s_add_u32 s12, s12, s13
    s_lshl_b32 s24, s12, 7
    v_mfma_f32_16x16x32_bf16 v[152:155], v[216:219], a[4:7], v[152:155]
    ds_read_b128 a[36:39], v211 offset:8192
    s_mul_i32 s12, s12, 18432
    s_lshl_b32 s13, s7, 11
    v_mfma_f32_16x16x32_bf16 v[156:159], a[4:7], a[4:7], v[156:159]
    s_add_u32 m0, m0, 1024
    s_add_u32 s20, s20, 4608
    buffer_load_dwordx4 v4, s[36:39], s20 offen lds
    s_add_u32 s23, s12, s13
    s_and_b32 s13, s3, 1
    v_mfma_f32_16x16x32_bf16 v[152:155], v[216:219], a[8:11], v[152:155]
    ds_read_b128 a[40:43], v210 offset:10240
    s_lshl_b32 s12, s13, 3
    s_lshl_b32 s13, s13, 4
    v_mfma_f32_16x16x32_bf16 v[156:159], a[8:11], a[8:11], v[156:159]
    s_waitcnt lgkmcnt(6)
    v_add_u32 v222, s13, v2
    v_lshrrev_b32 v223, 1, v1
    v_mfma_f32_16x16x32_bf16 v[152:155], v[216:219], a[12:15], v[152:155]
    ds_read_b128 a[44:47], v211 offset:10240
    s_add_u32 m0, m0, 1024
    s_add_u32 s20, s20, 13824
    buffer_load_dwordx4 v4, s[36:39], s20 offen lds
    v_lshlrev_b32 v22, 3, v0
    v_min_u32 v22, 248, v22
    v_mfma_f32_16x16x32_bf16 v[156:159], a[12:15], a[12:15], v[156:159]
    v_add_u32 v22, s24, v22
    v_add_u32 v22, 2555904, v22
    v_mfma_f32_16x16x32_bf16 v[152:155], v[216:219], a[16:19], v[152:155]
    ds_read_b128 a[48:51], v210 offset:12288
    s_add_u32 s24, s24, s12
    v_mfma_f32_16x16x32_bf16 v[156:159], a[16:19], a[16:19], v[156:159]
    s_waitcnt lgkmcnt(6)
    s_add_u32 m0, m0, 1024
    s_add_u32 s20, s20, 4608
    buffer_load_dwordx4 v4, s[36:39], s20 offen lds
    s_lshl_b32 s12, s7, 4
    s_add_u32 s24, s24, s12
    v_mfma_f32_16x16x32_bf16 v[152:155], v[216:219], a[20:23], v[152:155]
    ds_read_b128 a[52:55], v211 offset:12288
    s_lshl_b32 s12, s7, 2
    s_add_u32 s12, s12, 0
    v_mfma_f32_16x16x32_bf16 v[156:159], a[20:23], a[20:23], v[156:159]
    v_add_u32 v29, s12, v223
    v_mul_u32_u24 v29, 57, v29
    v_mfma_f32_16x16x32_bf16 v[152:155], v[216:219], a[24:27], v[152:155]
    ds_read_b128 a[56:59], v210 offset:14336
    s_add_u32 m0, m0, 1024
    s_add_u32 s20, s20, 13824
    buffer_load_dwordx4 v4, s[36:39], s20 offen lds
    v_lshrrev_b32 v29, 9, v29
    v_lshlrev_b32 v29, 3, v29
    v_mfma_f32_16x16x32_bf16 v[156:159], a[24:27], a[24:27], v[156:159]
    s_waitcnt lgkmcnt(6)
    ds_read_b64 v[240:241], v212
    v_mov_b32 v30, 0x00040103
    v_lshrrev_b32 v29, v29, v30
    v_mfma_f32_16x16x32_bf16 v[152:155], v[216:219], a[28:31], v[152:155]
    ds_read_b128 a[60:63], v211 offset:14336
    v_and_b32 v29, 7, v29
    v_add_u32 v29, v29, v222
    v_mfma_f32_16x16x32_bf16 v[156:159], a[28:31], a[28:31], v[156:159]
    ds_read_b64 v[242:243], v213
    s_add_u32 m0, m0, 1024
    s_add_u32 s20, s20, 4608
    buffer_load_dwordx4 v4, s[36:39], s20 offen lds
    v_subrev_u32 v29, 2, v29
    v_cmp_gt_u32 s[96:97], 32, v29
    v_mfma_f32_16x16x32_bf16 v[152:155], v[216:219], a[32:35], v[152:155]
    ds_read_b128 a[64:67], v210 offset:16384
    v_bfe_u32 v30, v29, 4, 1
    v_and_b32 v29, 15, v29
    v_mfma_f32_16x16x32_bf16 v[156:159], a[32:35], a[32:35], v[156:159]
    s_waitcnt lgkmcnt(8)
    ds_read_b64 v[244:245], v214
    v_mul_u32_u24 v30, 18432, v30
    v_mfma_f32_16x16x32_bf16 v[152:155], v[216:219], a[36:39], v[152:155]
    ds_read_b128 a[68:71], v211 offset:16384
    s_add_u32 m0, m0, 1024
    s_add_u32 s20, s20, 13824
    buffer_load_dwordx4 v4, s[36:39], s20 offen lds
    v_lshl_add_u32 v30, v29, 4, v30
    v_lshl_add_u32 v220, v1, 8, v30
    v_mfma_f32_16x16x32_bf16 v[156:159], a[36:39], a[36:39], v[156:159]
    ds_read_b64 v[246:247], v215
    s_lshl_b32 s12, s7, 2
    s_add_u32 s12, s12, 2
    v_mfma_f32_16x16x32_bf16 v[152:155], v[216:219], a[40:43], v[152:155]
    v_add_u32 v29, s12, v223
    v_mul_u32_u24 v29, 57, v29
    v_mfma_f32_16x16x32_bf16 v[156:159], a[40:43], a[40:43], v[156:159]
    s_waitcnt lgkmcnt(9)
    s_add_u32 m0, m0, 1024
    s_add_u32 s20, s20, 4608
    buffer_load_dwordx4 v4, s[36:39], s20 offen lds
    v_lshrrev_b32 v29, 9, v29
    v_lshlrev_b32 v29, 3, v29
    v_mfma_f32_16x16x32_bf16 v[152:155], v[216:219], a[44:47], v[152:155]
    v_mov_b32 v30, 0x00040103
    v_lshrrev_b32 v29, v29, v30
    v_mfma_f32_16x16x32_bf16 v[156:159], a[44:47], a[44:47], v[156:159]
    v_and_b32 v29, 7, v29
    v_add_u32 v29, v29, v222
    v_mfma_f32_16x16x32_bf16 v[152:155], v[216:219], a[48:51], v[152:155]
    v_subrev_u32 v29, 2, v29
    v_cmp_gt_u32 s[98:99], 32, v29
    v_mfma_f32_16x16x32_bf16 v[156:159], a[48:51], a[48:51], v[156:159]
    s_waitcnt lgkmcnt(6)
    v_bfe_u32 v30, v29, 4, 1
    v_and_b32 v29, 15, v29
    v_mfma_f32_16x16x32_bf16 v[152:155], v[216:219], a[52:55], v[152:155]
    v_mul_u32_u24 v30, 18432, v30
    v_mfma_f32_16x16x32_bf16 v[156:159], a[52:55], a[52:55], v[156:159]
    v_lshl_add_u32 v30, v29, 4, v30
    v_lshl_add_u32 v221, v1, 8, v30
    v_mfma_f32_16x16x32_bf16 v[152:155], v[216:219], a[56:59], v[152:155]
    v_add_u32 v14, 0, v6
    v_add_u32 v252, 36864, v6
    v_mfma_f32_16x16x32_bf16 v[156:159], a[56:59], a[56:59], v[156:159]
    s_waitcnt lgkmcnt(2)
    v_add_u32 v15, 0, v7
    v_add_u32 v253, 36864, v7
    v_mfma_f32_16x16x32_bf16 v[152:155], v[216:219], a[60:63], v[152:155]
    v_add_u32 v16, 0, v8
    v_add_u32 v254, 36864, v8
    v_mfma_f32_16x16x32_bf16 v[156:159], a[60:63], a[60:63], v[156:159]
    v_add_u32 v17, 0, v9
    v_add_u32 v255, 36864, v9
    v_mfma_f32_16x16x32_bf16 v[152:155], v[216:219], a[64:67], v[152:155]
    s_lshl_b32 s12, s3, 5
    v_xor_b32 v224, s12, v6
    v_mfma_f32_16x16x32_bf16 v[156:159], a[64:67], a[64:67], v[156:159]
    s_waitcnt lgkmcnt(0)
    v_add_u32 v225, 36864, v224
    s_lshl_b32 s12, s3, 7
    v_mfma_f32_16x16x32_bf16 v[152:155], v[216:219], a[68:71], v[152:155]
    v_lshlrev_b32 v226, 3, v2
    v_add_u32 v226, 151552, v226
    v_mfma_f32_16x16x32_bf16 v[156:159], a[68:71], a[68:71], v[156:159]
    v_add_u32 v227, s12, v226
    v_lshrrev_b32 v29, 3, v0
    v_and_b32 v30, 6, v29
    v_and_b32 v31, 7, v0
    v_xor_b32 v30, v30, v31
    v_lshlrev_b32 v30, 2, v30
    v_mov_b32 v31, 0x75643120
    v_lshrrev_b32 v30, v30, v31
    v_and_b32 v30, 7, v30

    v_mul_u32_u24 v4, 1152, v29
    v_lshl_add_u32 v4, v30, 4, v4
    v_and_b32 v29, 3, v2
    v_cmp_eq_u32 vcc, 1, v29
    v_cmp_eq_u32 s[12:13], 2, v29
    v_lshrrev_b32 v30, 2, v2
    v_cndmask_b32 v156, v156, v157, vcc
    v_cmp_eq_u32 vcc, 3, v29
    v_cndmask_b32 v156, v156, v158, s[12:13]
    v_cmp_eq_u32 s[12:13], v30, v1
    v_cndmask_b32 v156, v156, v159, vcc
    s_nop 0
    v_cndmask_b32 v156, 0, v156, s[12:13]

    v_mov_b32 v231, v156
    s_nop 1
    v_permlane16_swap_b32 v156, v231
    s_nop 1
    v_add_f32 v156, v156, v231
    v_mov_b32 v231, v156
    s_nop 1
    v_permlane32_swap_b32 v156, v231
    s_nop 1
    v_add_f32 v156, v156, v231

    v_mul_f32 v228, 0x3ae38e39, v152
    v_mul_f32 v231, 0x3ae38e39, v156
    v_fma_f32 v231, -v228, v228, v231
    v_max_f32 v231, 0, v231
    v_cvt_pk_bf16_f32 v231, v231, v228
    v_and_b32 v228, 0xffff0000, v231
    v_lshlrev_b32 v231, 16, v231
    v_add_f32 v231, 0x3727c5ac, v231
    v_cvt_pk_bf16_f32 v231, v231, v231
    v_lshlrev_b32 v231, 16, v231
    v_sqrt_f32 v231, v231
    s_nop 0
    v_cvt_pk_bf16_f32 v231, v231, v231
    v_lshlrev_b32 v229, 16, v231

    v_rcp_f32 v230, v229
    v_cvt_pk_bf16_f32 v232, -v228, -v228
    v_cmp_eq_u32 vcc, 0, v1
    v_mov_b32 v235, 0
    v_mov_b32 v234, 0
    v_cndmask_b32 v232, 0, v232, vcc
    v_mov_b32 v233, v232

    v_mov_b32 v162, 0
    v_mov_b32 v163, 0
    v_mov_b32 v166, 0
    v_mov_b32 v167, 0
    v_mov_b32 v170, 0
    v_mov_b32 v171, 0
    v_mov_b32 v174, 0
    v_mov_b32 v175, 0
    s_waitcnt vmcnt(0)
    s_barrier
    ds_read_b64_tr_b16 v[104:105], v224 offset:0
    ds_read_b64_tr_b16 v[106:107], v224 offset:1024
    ds_read_b64_tr_b16 v[108:109], v224 offset:4096
    ds_read_b64_tr_b16 v[110:111], v224 offset:5120
    ds_read_b64_tr_b16 v[112:113], v224 offset:8192
    ds_read_b64_tr_b16 v[114:115], v224 offset:9216
    ds_read_b64_tr_b16 v[116:117], v224 offset:12288
    ds_read_b64_tr_b16 v[118:119], v224 offset:13312
    ds_read_b64_tr_b16 v[120:121], v224 offset:16384
    ds_read_b64_tr_b16 v[122:123], v224 offset:17408
    ds_read_b64_tr_b16 v[124:125], v224 offset:20480
    ds_read_b64_tr_b16 v[126:127], v224 offset:21504
    s_waitcnt lgkmcnt(10)
    v_mfma_f32_16x16x32_bf16 v[152:155], v[216:219], v[104:107], 0
    s_waitcnt lgkmcnt(4)
    ds_read_b64_tr_b16 v[128:129], v224 offset:24576
    ds_read_b64_tr_b16 v[130:131], v224 offset:25600
    buffer_load_dwordx2 v[24:25], v3, s[60:63], 0 offen sc1
    v_mfma_f32_16x16x32_bf16 v[152:155], v[216:219], v[108:111], v[152:155]
    ds_read_b64_tr_b16 v[132:133], v224 offset:28672
    ds_read_b64_tr_b16 v[134:135], v224 offset:29696
    buffer_load_dwordx2 v[20:21], v22, s[52:55], 0 offen offset:0 sc1
    v_mfma_f32_16x16x32_bf16 v[152:155], v[216:219], v[112:115], v[152:155]
    ds_read_b64_tr_b16 v[104:105], v224 offset:32768
    ds_read_b64_tr_b16 v[106:107], v224 offset:33792
    s_add_u32 s12, s3, 0
    s_min_u32 s12, s12, 1

    s_lshl_b32 s13, s12, 10
    s_add_u32 m0, s13, 147456
    s_add_u32 s12, s12, s18
    s_add_u32 s12, s12, 16
    s_sub_u32 s13, s12, 18
    s_cmp_ge_u32 s12, 18
    s_cselect_b32 s12, s13, s12
    s_mul_i32 s12, s12, 294912

    buffer_load_dwordx4 v5, s[44:47], s12 offen lds
    v_mfma_f32_16x16x32_bf16 v[152:155], v[216:219], v[116:119], v[152:155]
    s_waitcnt lgkmcnt(4)
    ds_read_b64_tr_b16 v[108:109], v225 offset:0
    ds_read_b64_tr_b16 v[110:111], v225 offset:1024
    v_mfma_f32_16x16x32_bf16 v[152:155], v[216:219], v[120:123], v[152:155]
    ds_read_b64_tr_b16 v[112:113], v225 offset:4096
    ds_read_b64_tr_b16 v[114:115], v225 offset:5120
    s_lshl_b32 s12, s9, 3
    s_lshl_b32 s13, s3, 1
    v_mfma_f32_16x16x32_bf16 v[152:155], v[216:219], v[124:127], v[152:155]
    ds_read_b64_tr_b16 v[116:117], v225 offset:8192
    ds_read_b64_tr_b16 v[118:119], v225 offset:9216
    s_add_u32 s19, s12, s13
    v_add_u32 v11, 18432, v10
    v_mfma_f32_16x16x32_bf16 v[152:155], v[216:219], v[128:131], v[152:155]
    s_waitcnt lgkmcnt(4)
    ds_read_b64_tr_b16 v[120:121], v225 offset:12288
    ds_read_b64_tr_b16 v[122:123], v225 offset:13312
    s_mul_i32 s0, s4, 663552
    s_lshl_b32 s12, s19, 3
    v_mfma_f32_16x16x32_bf16 v[152:155], v[216:219], v[132:135], v[152:155]
    ds_read_b64_tr_b16 v[124:125], v225 offset:16384
    ds_read_b64_tr_b16 v[126:127], v225 offset:17408
    s_add_u32 s12, s12, s4
    s_mul_i32 s1, s12, 18432
    v_mfma_f32_16x16x32_bf16 v[152:155], v[216:219], v[104:107], v[152:155]
    ds_read_b64_tr_b16 v[128:129], v225 offset:20480
    ds_read_b64_tr_b16 v[130:131], v225 offset:21504
    s_add_u32 s1, s1, 3145728
    v_and_b32 v29, 1, v1
    v_mfma_f32_16x16x32_bf16 v[152:155], v[216:219], v[108:111], v[152:155]
    s_waitcnt lgkmcnt(4)
    ds_read_b64_tr_b16 v[132:133], v225 offset:24576
    ds_read_b64_tr_b16 v[134:135], v225 offset:25600
    v_lshlrev_b32 v23, 8, v29
    v_mfma_f32_16x16x32_bf16 v[152:155], v[216:219], v[112:115], v[152:155]
    ds_read_b64_tr_b16 v[104:105], v225 offset:28672
    ds_read_b64_tr_b16 v[106:107], v225 offset:29696
    v_lshl_add_u32 v23, v2, 4, v23
    v_lshrrev_b32 v29, 1, v1
    v_mfma_f32_16x16x32_bf16 v[152:155], v[216:219], v[116:119], v[152:155]
    ds_read_b64_tr_b16 v[108:109], v225 offset:32768
    ds_read_b64_tr_b16 v[110:111], v225 offset:33792
    v_lshl_add_u32 v23, v29, 3, v23
    v_add_u32 v12, 147456, v10
    v_mfma_f32_16x16x32_bf16 v[152:155], v[216:219], v[120:123], v[152:155]
    s_waitcnt lgkmcnt(4)
    ds_read_b64_tr_b16 v[112:113], v14 offset:0
    ds_read_b64_tr_b16 v[114:115], v14 offset:1024
    s_lshl_b32 s12, s9, 3
    s_add_u32 s12, s12, s4
    v_mfma_f32_16x16x32_bf16 v[152:155], v[216:219], v[124:127], v[152:155]
    ds_read_b64_tr_b16 v[116:117], v15 offset:0
    ds_read_b64_tr_b16 v[118:119], v15 offset:1024
    s_lshl_b32 s12, s12, 2
    s_add_u32 s12, s12, s3
    v_mfma_f32_16x16x32_bf16 v[152:155], v[216:219], v[128:131], v[152:155]
    ds_read_b64_tr_b16 v[120:121], v16 offset:0
    ds_read_b64_tr_b16 v[122:123], v16 offset:1024
    s_lshl_b32 s12, s12, 10
    v_mfma_f32_16x16x32_bf16 v[152:155], v[216:219], v[132:135], v[152:155]
    s_waitcnt lgkmcnt(4)
    ds_read_b64_tr_b16 v[124:125], v17 offset:0
    ds_read_b64_tr_b16 v[126:127], v17 offset:1024
    s_add_u32 s10, s12, 2621440
    s_lshl_b32 s12, s8, 3
    v_mfma_f32_16x16x32_bf16 v[152:155], v[216:219], v[104:107], v[152:155]
    ds_read_b64_tr_b16 v[128:129], v14 offset:4096
    ds_read_b64_tr_b16 v[130:131], v14 offset:5120
    s_add_u32 s22, s10, s12
    s_lshl_b32 s12, s19, 11
    v_mfma_f32_16x16x32_bf16 v[152:155], v[216:219], v[108:111], v[152:155]
    ds_read_b64_tr_b16 v[132:133], v15 offset:4096
    ds_read_b64_tr_b16 v[134:135], v15 offset:5120
    s_add_u32 s12, s12, 2359296
    v_mul_u32_u24 v80, 384, v1
    v_mfma_f32_16x16x32_bf16 v[136:139], v[112:115], a[0:3], 0
    s_waitcnt lgkmcnt(4)
    ds_read_b64_tr_b16 v[104:105], v16 offset:4096
    ds_read_b64_tr_b16 v[106:107], v16 offset:5120
    v_lshl_add_u32 v80, v2, 3, v80
    v_add_u32 v80, s12, v80
    v_mfma_f32_16x16x32_bf16 v[140:143], v[116:119], a[0:3], 0
    ds_read_b64_tr_b16 v[108:109], v17 offset:4096
    ds_read_b64_tr_b16 v[110:111], v17 offset:5120
    v_mov_b32 v31, 0x7ff00000
    v_mfma_f32_16x16x32_bf16 v[144:147], v[120:123], a[0:3], 0
    ds_read_b64_tr_b16 v[112:113], v14 offset:8192
    ds_read_b64_tr_b16 v[114:115], v14 offset:9216
    v_cmp_gt_u32 vcc, 48, v0
    s_lshl_b32 s13, s16, 10
    v_mfma_f32_16x16x32_bf16 v[148:151], v[124:127], a[0:3], 0
    s_waitcnt lgkmcnt(4)
    ds_read_b64_tr_b16 v[116:117], v15 offset:8192
    ds_read_b64_tr_b16 v[118:119], v15 offset:9216
    s_add_u32 s13, s13, 2490368
    v_cndmask_b32 v80, v31, v80, vcc
    v_mfma_f32_16x16x32_bf16 v[136:139], v[128:131], a[4:7], v[136:139]
    ds_read_b64_tr_b16 v[120:121], v16 offset:8192
    ds_read_b64_tr_b16 v[122:123], v16 offset:9216
    v_lshlrev_b32 v81, 3, v2
    v_add_u32 v81, s13, v81
    v_mfma_f32_16x16x32_bf16 v[140:143], v[132:135], a[4:7], v[140:143]
    ds_read_b64_tr_b16 v[124:125], v17 offset:8192
    ds_read_b64_tr_b16 v[126:127], v17 offset:9216
    s_lshl_b32 s12, s9, 2
    s_add_u32 s12, s12, s8
    v_mfma_f32_16x16x32_bf16 v[144:147], v[104:107], a[4:7], v[144:147]
    s_waitcnt lgkmcnt(4)
    ds_read_b64_tr_b16 v[128:129], v14 offset:12288
    ds_read_b64_tr_b16 v[130:131], v14 offset:13312
    s_mul_i32 s12, s12, 589824
    v_and_b32 v153, 0xffff0000, v152
    v_sub_f32 v152, v152, v153
    v_mfma_f32_16x16x32_bf16 v[148:151], v[108:111], a[4:7], v[148:151]
    ds_read_b64_tr_b16 v[132:133], v15 offset:12288
    ds_read_b64_tr_b16 v[134:135], v15 offset:13312
    s_add_u32 s11, s12, 12582912
    s_lshl_b32 s12, s4, 12
    v_and_b32 v154, 0xffff0000, v152
    v_mfma_f32_16x16x32_bf16 v[136:139], v[112:115], a[8:11], v[136:139]
    ds_read_b64_tr_b16 v[104:105], v16 offset:12288
    ds_read_b64_tr_b16 v[106:107], v16 offset:13312
    s_lshl_b32 s13, s3, 10
    s_add_u32 s12, s12, s13
    v_sub_f32 v152, v152, v154
    v_cvt_pk_bf16_f32 v154, v153, v154
    v_mfma_f32_16x16x32_bf16 v[140:143], v[116:119], a[8:11], v[140:143]
    s_waitcnt lgkmcnt(4)
    ds_read_b64_tr_b16 v[108:109], v17 offset:12288
    ds_read_b64_tr_b16 v[110:111], v17 offset:13312
    s_add_u32 s12, s12, s11
    v_add_u32 v78, s12, v10
    v_cvt_pk_bf16_f32 v155, v152, 0
    v_mfma_f32_16x16x32_bf16 v[144:147], v[120:123], a[8:11], v[144:147]
    ds_read_b64_tr_b16 v[112:113], v14 offset:16384
    ds_read_b64_tr_b16 v[114:115], v14 offset:17408
    s_lshl_b32 s12, s4, 3
    s_lshl_b32 s13, s3, 6
    v_mfma_f32_16x16x32_bf16 v[148:151], v[124:127], a[8:11], v[148:151]
    ds_read_b64_tr_b16 v[116:117], v15 offset:16384
    ds_read_b64_tr_b16 v[118:119], v15 offset:17408
    s_add_u32 s12, s12, s13
    v_mfma_f32_16x16x32_bf16 v[136:139], v[128:131], a[12:15], v[136:139]
    s_waitcnt lgkmcnt(4)
    ds_read_b64_tr_b16 v[120:121], v16 offset:16384
    ds_read_b64_tr_b16 v[122:123], v16 offset:17408
    s_add_u32 s12, s12, s11
    s_add_u32 s12, s12, 32768
    v_mfma_f32_16x16x32_bf16 v[140:143], v[132:135], a[12:15], v[140:143]
    ds_read_b64_tr_b16 v[124:125], v17 offset:16384
    ds_read_b64_tr_b16 v[126:127], v17 offset:17408
    v_add_u32 v79, s12, v19
    v_mul_u32_u24 v77, 1152, v2
    v_mfma_f32_16x16x32_bf16 v[144:147], v[104:107], a[12:15], v[144:147]
    ds_read_b64_tr_b16 v[128:129], v14 offset:20480
    ds_read_b64_tr_b16 v[130:131], v14 offset:21504
    v_lshl_add_u32 v77, v1, 3, v77
    s_add_u32 s12, s8, 0
    v_mfma_f32_16x16x32_bf16 v[148:151], v[108:111], a[12:15], v[148:151]
    s_waitcnt lgkmcnt(4)
    ds_read_b64_tr_b16 v[132:133], v15 offset:20480
    ds_read_b64_tr_b16 v[134:135], v15 offset:21504
    s_and_b32 s12, s12, 3
    s_lshl_b32 s88, s12, 2
    v_mfma_f32_16x16x32_bf16 v[136:139], v[112:115], a[16:19], v[136:139]
    ds_read_b64_tr_b16 v[104:105], v16 offset:20480
    ds_read_b64_tr_b16 v[106:107], v16 offset:21504
    s_lshl_b32 s12, s12, 12
    v_mfma_f32_16x16x32_bf16 v[140:143], v[116:119], a[16:19], v[140:143]
    ds_read_b64_tr_b16 v[108:109], v17 offset:20480
    ds_read_b64_tr_b16 v[110:111], v17 offset:21504
    s_add_u32 s92, s12, s1
    s_add_u32 s12, s8, 1
    v_mfma_f32_16x16x32_bf16 v[144:147], v[120:123], a[16:19], v[144:147]
    s_waitcnt lgkmcnt(4)
    ds_read_b64_tr_b16 v[112:113], v14 offset:24576
    ds_read_b64_tr_b16 v[114:115], v14 offset:25600
    s_and_b32 s12, s12, 3
    s_lshl_b32 s89, s12, 2
    v_mfma_f32_16x16x32_bf16 v[148:151], v[124:127], a[16:19], v[148:151]
    ds_read_b64_tr_b16 v[116:117], v15 offset:24576
    ds_read_b64_tr_b16 v[118:119], v15 offset:25600
    s_lshl_b32 s12, s12, 12
    s_add_u32 s93, s12, s1
    v_mfma_f32_16x16x32_bf16 v[136:139], v[128:131], a[20:23], v[136:139]
    ds_read_b64_tr_b16 v[120:121], v16 offset:24576
    ds_read_b64_tr_b16 v[122:123], v16 offset:25600
    s_add_u32 s12, s8, 2
    s_and_b32 s12, s12, 3
    v_mfma_f32_16x16x32_bf16 v[140:143], v[132:135], a[20:23], v[140:143]
    s_waitcnt lgkmcnt(4)
    ds_read_b64_tr_b16 v[124:125], v17 offset:24576
    ds_read_b64_tr_b16 v[126:127], v17 offset:25600
    s_lshl_b32 s90, s12, 2
    v_mfma_f32_16x16x32_bf16 v[144:147], v[104:107], a[20:23], v[144:147]
    ds_read_b64_tr_b16 v[128:129], v14 offset:28672
    ds_read_b64_tr_b16 v[130:131], v14 offset:29696
    s_lshl_b32 s12, s12, 12
    s_add_u32 s94, s12, s1
    v_mfma_f32_16x16x32_bf16 v[148:151], v[108:111], a[20:23], v[148:151]
    ds_read_b64_tr_b16 v[132:133], v15 offset:28672
    ds_read_b64_tr_b16 v[134:135], v15 offset:29696
    s_add_u32 s12, s8, 3
    s_and_b32 s12, s12, 3
    v_mfma_f32_16x16x32_bf16 v[136:139], v[112:115], a[24:27], v[136:139]
    s_waitcnt lgkmcnt(4)
    ds_read_b64_tr_b16 v[104:105], v16 offset:28672
    ds_read_b64_tr_b16 v[106:107], v16 offset:29696
    s_lshl_b32 s91, s12, 2
    s_lshl_b32 s12, s12, 12
    v_mfma_f32_16x16x32_bf16 v[140:143], v[116:119], a[24:27], v[140:143]
    ds_read_b64_tr_b16 v[108:109], v17 offset:28672
    ds_read_b64_tr_b16 v[110:111], v17 offset:29696
    s_add_u32 s95, s12, s1
    v_mov_b32 v60, 0
    v_mfma_f32_16x16x32_bf16 v[144:147], v[120:123], a[24:27], v[144:147]
    ds_read_b64_tr_b16 v[112:113], v14 offset:32768
    ds_read_b64_tr_b16 v[114:115], v14 offset:33792
    v_mov_b32 v61, 0
    v_mfma_f32_16x16x32_bf16 v[148:151], v[124:127], a[24:27], v[148:151]
    s_waitcnt lgkmcnt(4)
    ds_read_b64_tr_b16 v[116:117], v15 offset:32768
    ds_read_b64_tr_b16 v[118:119], v15 offset:33792
    v_mov_b32 v62, 0
    v_mov_b32 v63, 0
    v_mfma_f32_16x16x32_bf16 v[136:139], v[128:131], a[28:31], v[136:139]
    ds_read_b64_tr_b16 v[120:121], v16 offset:32768
    ds_read_b64_tr_b16 v[122:123], v16 offset:33792
    v_mov_b32 v64, 0
    v_mov_b32 v65, 0
    v_mfma_f32_16x16x32_bf16 v[140:143], v[132:135], a[28:31], v[140:143]
    ds_read_b64_tr_b16 v[124:125], v17 offset:32768
    ds_read_b64_tr_b16 v[126:127], v17 offset:33792
    v_mov_b32 v66, 0
    v_mov_b32 v67, 0
    v_mfma_f32_16x16x32_bf16 v[144:147], v[104:107], a[28:31], v[144:147]
    s_waitcnt lgkmcnt(4)
    ds_read_b64_tr_b16 v[128:129], v252 offset:0
    ds_read_b64_tr_b16 v[130:131], v252 offset:1024
    v_lshlrev_b32 v29, 21, v2
    v_add_u32 v29, 0x1ff000, v29
    s_lshl_b32 s12, s9, 2
    s_add_u32 s12, s12, s3
    s_lshl_b32 s12, s12, 8
    s_add_u32 s12, s12, 2564096
    v_writelane_b32 v29, s12, 0
    s_add_u32 s12, s12, 128
    v_writelane_b32 v29, s12, 1
    s_lshl_b32 s13, s16, 6
    s_add_u32 s13, s13, 2572288
    v_writelane_b32 v29, s13, 2
    v_writelane_b32 v29, s10, 3
    s_add_u32 s12, s10, 128
    v_writelane_b32 v29, s12, 4
    s_add_u32 s12, s12, 128
    v_writelane_b32 v29, s12, 7
    s_add_u32 s12, s12, 128
    v_writelane_b32 v29, s12, 8
    s_lshl_b32 s12, s4, 16
    s_lshl_b32 s13, s3, 6
    s_add_u32 s12, s12, s13
    s_add_u32 s12, s12, s11
    s_add_u32 s12, s12, 32768
    v_writelane_b32 v29, s12, 5
    s_lshr_b32 s13, s4, 1
    s_lshl_b32 s13, s13, 6
    s_add_u32 s12, s13, s11
    s_add_u32 s12, s12, 557056
    v_writelane_b32 v29, s12, 6

    buffer_load_dword v249, v29, s[52:55], 0 offen sc1
    buffer_load_dword v248, v19, s[56:59], 0 offen
    v_mfma_f32_16x16x32_bf16 v[148:151], v[108:111], a[28:31], v[148:151]
    ds_read_b64_tr_b16 v[132:133], v253 offset:0
    ds_read_b64_tr_b16 v[134:135], v253 offset:1024
    v_mfma_f32_16x16x32_bf16 v[136:139], v[112:115], a[32:35], v[136:139]
    ds_read_b64_tr_b16 v[104:105], v254 offset:0
    ds_read_b64_tr_b16 v[106:107], v254 offset:1024
    v_mfma_f32_16x16x32_bf16 v[140:143], v[116:119], a[32:35], v[140:143]
    s_waitcnt lgkmcnt(4)
    ds_read_b64_tr_b16 v[108:109], v255 offset:0
    ds_read_b64_tr_b16 v[110:111], v255 offset:1024
    v_mfma_f32_16x16x32_bf16 v[144:147], v[120:123], a[32:35], v[144:147]
    ds_read_b64_tr_b16 v[112:113], v252 offset:4096
    ds_read_b64_tr_b16 v[114:115], v252 offset:5120
    v_mfma_f32_16x16x32_bf16 v[148:151], v[124:127], a[32:35], v[148:151]
    ds_read_b64_tr_b16 v[116:117], v253 offset:4096
    ds_read_b64_tr_b16 v[118:119], v253 offset:5120
    v_mfma_f32_16x16x32_bf16 v[136:139], v[128:131], a[36:39], v[136:139]
    s_waitcnt lgkmcnt(4)
    ds_read_b64_tr_b16 v[120:121], v254 offset:4096
    ds_read_b64_tr_b16 v[122:123], v254 offset:5120
    v_mfma_f32_16x16x32_bf16 v[140:143], v[132:135], a[36:39], v[140:143]
    ds_read_b64_tr_b16 v[124:125], v255 offset:4096
    ds_read_b64_tr_b16 v[126:127], v255 offset:5120
    v_mfma_f32_16x16x32_bf16 v[144:147], v[104:107], a[36:39], v[144:147]
    ds_read_b64_tr_b16 v[128:129], v252 offset:8192
    ds_read_b64_tr_b16 v[130:131], v252 offset:9216
    v_mfma_f32_16x16x32_bf16 v[148:151], v[108:111], a[36:39], v[148:151]
    s_waitcnt lgkmcnt(4)
    ds_read_b64_tr_b16 v[132:133], v253 offset:8192
    ds_read_b64_tr_b16 v[134:135], v253 offset:9216
    v_mfma_f32_16x16x32_bf16 v[136:139], v[112:115], a[40:43], v[136:139]
    ds_read_b64_tr_b16 v[104:105], v254 offset:8192
    ds_read_b64_tr_b16 v[106:107], v254 offset:9216
    v_mfma_f32_16x16x32_bf16 v[140:143], v[116:119], a[40:43], v[140:143]
    ds_read_b64_tr_b16 v[108:109], v255 offset:8192
    ds_read_b64_tr_b16 v[110:111], v255 offset:9216
    v_mfma_f32_16x16x32_bf16 v[144:147], v[120:123], a[40:43], v[144:147]
    s_waitcnt lgkmcnt(4)
    ds_read_b64_tr_b16 v[112:113], v252 offset:12288
    ds_read_b64_tr_b16 v[114:115], v252 offset:13312
    v_mfma_f32_16x16x32_bf16 v[148:151], v[124:127], a[40:43], v[148:151]
    ds_read_b64_tr_b16 v[116:117], v253 offset:12288
    ds_read_b64_tr_b16 v[118:119], v253 offset:13312
    v_mfma_f32_16x16x32_bf16 v[136:139], v[128:131], a[44:47], v[136:139]
    ds_read_b64_tr_b16 v[120:121], v254 offset:12288
    ds_read_b64_tr_b16 v[122:123], v254 offset:13312
    v_mfma_f32_16x16x32_bf16 v[140:143], v[132:135], a[44:47], v[140:143]
    s_waitcnt lgkmcnt(4)
    ds_read_b64_tr_b16 v[124:125], v255 offset:12288
    ds_read_b64_tr_b16 v[126:127], v255 offset:13312
    v_mfma_f32_16x16x32_bf16 v[144:147], v[104:107], a[44:47], v[144:147]
    ds_read_b64_tr_b16 v[128:129], v252 offset:16384
    ds_read_b64_tr_b16 v[130:131], v252 offset:17408
    v_mfma_f32_16x16x32_bf16 v[148:151], v[108:111], a[44:47], v[148:151]
    ds_read_b64_tr_b16 v[132:133], v253 offset:16384
    ds_read_b64_tr_b16 v[134:135], v253 offset:17408
    v_mfma_f32_16x16x32_bf16 v[136:139], v[112:115], a[48:51], v[136:139]
    s_waitcnt lgkmcnt(4)
    ds_read_b64_tr_b16 v[104:105], v254 offset:16384
    ds_read_b64_tr_b16 v[106:107], v254 offset:17408
    v_mfma_f32_16x16x32_bf16 v[140:143], v[116:119], a[48:51], v[140:143]
    ds_read_b64_tr_b16 v[108:109], v255 offset:16384
    ds_read_b64_tr_b16 v[110:111], v255 offset:17408
    v_mfma_f32_16x16x32_bf16 v[144:147], v[120:123], a[48:51], v[144:147]
    ds_read_b64_tr_b16 v[112:113], v252 offset:20480
    ds_read_b64_tr_b16 v[114:115], v252 offset:21504
    v_mfma_f32_16x16x32_bf16 v[148:151], v[124:127], a[48:51], v[148:151]
    s_waitcnt lgkmcnt(4)
    ds_read_b64_tr_b16 v[116:117], v253 offset:20480
    ds_read_b64_tr_b16 v[118:119], v253 offset:21504
    v_mfma_f32_16x16x32_bf16 v[136:139], v[128:131], a[52:55], v[136:139]
    ds_read_b64_tr_b16 v[120:121], v254 offset:20480
    ds_read_b64_tr_b16 v[122:123], v254 offset:21504
    v_mfma_f32_16x16x32_bf16 v[140:143], v[132:135], a[52:55], v[140:143]
    ds_read_b64_tr_b16 v[124:125], v255 offset:20480
    ds_read_b64_tr_b16 v[126:127], v255 offset:21504
    v_mfma_f32_16x16x32_bf16 v[144:147], v[104:107], a[52:55], v[144:147]
    s_waitcnt lgkmcnt(4)
    ds_read_b64_tr_b16 v[128:129], v252 offset:24576
    ds_read_b64_tr_b16 v[130:131], v252 offset:25600
    v_mfma_f32_16x16x32_bf16 v[148:151], v[108:111], a[52:55], v[148:151]
    ds_read_b64_tr_b16 v[132:133], v253 offset:24576
    ds_read_b64_tr_b16 v[134:135], v253 offset:25600
    v_mfma_f32_16x16x32_bf16 v[136:139], v[112:115], a[56:59], v[136:139]
    ds_read_b64_tr_b16 v[104:105], v254 offset:24576
    ds_read_b64_tr_b16 v[106:107], v254 offset:25600
    v_mfma_f32_16x16x32_bf16 v[140:143], v[116:119], a[56:59], v[140:143]
    s_waitcnt lgkmcnt(4)
    ds_read_b64_tr_b16 v[108:109], v255 offset:24576
    ds_read_b64_tr_b16 v[110:111], v255 offset:25600
    v_mfma_f32_16x16x32_bf16 v[144:147], v[120:123], a[56:59], v[144:147]
    ds_read_b64_tr_b16 v[112:113], v252 offset:28672
    ds_read_b64_tr_b16 v[114:115], v252 offset:29696
    v_mfma_f32_16x16x32_bf16 v[148:151], v[124:127], a[56:59], v[148:151]
    ds_read_b64_tr_b16 v[116:117], v253 offset:28672
    ds_read_b64_tr_b16 v[118:119], v253 offset:29696
    v_mfma_f32_16x16x32_bf16 v[136:139], v[128:131], a[60:63], v[136:139]
    s_waitcnt lgkmcnt(4)
    ds_read_b64_tr_b16 v[120:121], v254 offset:28672
    ds_read_b64_tr_b16 v[122:123], v254 offset:29696
    v_mfma_f32_16x16x32_bf16 v[140:143], v[132:135], a[60:63], v[140:143]
    ds_read_b64_tr_b16 v[124:125], v255 offset:28672
    ds_read_b64_tr_b16 v[126:127], v255 offset:29696
    v_mfma_f32_16x16x32_bf16 v[144:147], v[104:107], a[60:63], v[144:147]
    ds_read_b64_tr_b16 v[128:129], v252 offset:32768
    ds_read_b64_tr_b16 v[130:131], v252 offset:33792
    v_mfma_f32_16x16x32_bf16 v[148:151], v[108:111], a[60:63], v[148:151]
    s_waitcnt lgkmcnt(4)
    ds_read_b64_tr_b16 v[132:133], v253 offset:32768
    ds_read_b64_tr_b16 v[134:135], v253 offset:33792
    v_mfma_f32_16x16x32_bf16 v[136:139], v[112:115], a[64:67], v[136:139]
    ds_read_b64_tr_b16 v[104:105], v254 offset:32768
    ds_read_b64_tr_b16 v[106:107], v254 offset:33792
    v_mfma_f32_16x16x32_bf16 v[140:143], v[116:119], a[64:67], v[140:143]
    ds_read_b64_tr_b16 v[108:109], v255 offset:32768
    ds_read_b64_tr_b16 v[110:111], v255 offset:33792
    v_mfma_f32_16x16x32_bf16 v[144:147], v[120:123], a[64:67], v[144:147]
    s_waitcnt lgkmcnt(4)
    v_mfma_f32_16x16x32_bf16 v[148:151], v[124:127], a[64:67], v[148:151]
    v_mfma_f32_16x16x32_bf16 v[136:139], v[128:131], a[68:71], v[136:139]
    v_mfma_f32_16x16x32_bf16 v[140:143], v[132:135], a[68:71], v[140:143]
    s_waitcnt lgkmcnt(0)
    v_mfma_f32_16x16x32_bf16 v[144:147], v[104:107], a[68:71], v[144:147]
    v_mfma_f32_16x16x32_bf16 v[148:151], v[108:111], a[68:71], v[148:151]
    ds_write_b64 v227, v[154:155]
    v_mul_f32 v212, 0xc0135761, v230
    v_mul_f32 v213, v230, v230
    v_mul_f32 v213, v213, v230
    v_mul_f32 v213, 0xbdd2d3e8, v213
    s_add_u32 s12, s23, 0
    s_waitcnt lgkmcnt(0)
    s_barrier

    ds_read_b64 v[160:161], v226 offset:0
    ds_read_b64 v[164:165], v226 offset:128
    ds_read_b64 v[168:169], v226 offset:256
    ds_read_b64 v[172:173], v226 offset:384
    s_waitcnt lgkmcnt(3)
    v_mfma_f32_16x16x32_bf16 v[136:139], v[160:163], v[232:235], v[136:139]
    s_waitcnt lgkmcnt(2)
    v_mfma_f32_16x16x32_bf16 v[140:143], v[164:167], v[232:235], v[140:143]
    s_waitcnt lgkmcnt(1)
    v_mfma_f32_16x16x32_bf16 v[144:147], v[168:171], v[232:235], v[144:147]
    s_waitcnt lgkmcnt(0)
    v_mfma_f32_16x16x32_bf16 v[148:151], v[172:175], v[232:235], v[148:151]
    s_nop 7
    v_mul_f32 v184, v136, v136
    v_mul_f32 v185, v137, v137
    v_mul_f32 v186, v138, v138
    v_mul_f32 v187, v139, v139
    v_mul_f32 v188, v140, v140
    v_mul_f32 v189, v141, v141
    v_mul_f32 v190, v142, v142
    v_mul_f32 v191, v143, v143
    v_fma_f32 v184, v184, v213, v212
    v_fma_f32 v185, v185, v213, v212
    v_fma_f32 v186, v186, v213, v212
    v_fma_f32 v187, v187, v213, v212
    v_fma_f32 v188, v188, v213, v212
    v_fma_f32 v189, v189, v213, v212
    v_fma_f32 v190, v190, v213, v212
    v_fma_f32 v191, v191, v213, v212
    v_mul_f32 v184, v136, v184
    v_mul_f32 v185, v137, v185
    v_mul_f32 v186, v138, v186
    v_mul_f32 v187, v139, v187
    v_mul_f32 v188, v140, v188
    v_mul_f32 v189, v141, v189
    v_mul_f32 v190, v142, v190
    v_mul_f32 v191, v143, v191
    v_exp_f32 v184, v184
    v_exp_f32 v185, v185
    v_exp_f32 v186, v186
    v_exp_f32 v187, v187
    v_exp_f32 v188, v188
    v_exp_f32 v189, v189
    v_exp_f32 v190, v190
    v_exp_f32 v191, v191
    v_fma_f32 v184, v184, v229, v229
    v_fma_f32 v185, v185, v229, v229
    v_fma_f32 v186, v186, v229, v229
    v_fma_f32 v187, v187, v229, v229
    v_fma_f32 v188, v188, v229, v229
    v_fma_f32 v189, v189, v229, v229
    v_fma_f32 v190, v190, v229, v229
    v_fma_f32 v191, v191, v229, v229
    v_rcp_f32 v184, v184
    v_rcp_f32 v185, v185
    v_rcp_f32 v186, v186
    v_rcp_f32 v187, v187
    v_rcp_f32 v188, v188
    v_rcp_f32 v189, v189
    v_rcp_f32 v190, v190
    v_rcp_f32 v191, v191
    v_mul_f32 v136, v136, v184
    v_mul_f32 v137, v137, v185
    v_mul_f32 v138, v138, v186
    v_mul_f32 v139, v139, v187
    v_mul_f32 v140, v140, v188
    v_mul_f32 v141, v141, v189
    v_mul_f32 v142, v142, v190
    v_mul_f32 v143, v143, v191
    v_cvt_pk_bf16_f32 v176, v136, v137
    v_cvt_pk_bf16_f32 v177, v138, v139
    v_cvt_pk_bf16_f32 v178, v140, v141
    v_cvt_pk_bf16_f32 v179, v142, v143
    v_cndmask_b32 v176, 0, v176, s[96:97]
    v_cndmask_b32 v177, 0, v177, s[96:97]
    v_cndmask_b32 v178, 0, v178, s[96:97]
    v_cndmask_b32 v179, 0, v179, s[96:97]
    buffer_store_dwordx4 v[176:179], v220, s[52:55], s12 offen offset:0 sc1
    v_mul_f32 v184, v144, v144
    v_mul_f32 v185, v145, v145
    v_mul_f32 v186, v146, v146
    v_mul_f32 v187, v147, v147
    v_mul_f32 v188, v148, v148
    v_mul_f32 v189, v149, v149
    v_mul_f32 v190, v150, v150
    v_mul_f32 v191, v151, v151
    v_fma_f32 v184, v184, v213, v212
    v_fma_f32 v185, v185, v213, v212
    v_fma_f32 v186, v186, v213, v212
    v_fma_f32 v187, v187, v213, v212
    v_fma_f32 v188, v188, v213, v212
    v_fma_f32 v189, v189, v213, v212
    v_fma_f32 v190, v190, v213, v212
    v_fma_f32 v191, v191, v213, v212
    v_mul_f32 v184, v144, v184
    v_mul_f32 v185, v145, v185
    v_mul_f32 v186, v146, v186
    v_mul_f32 v187, v147, v187
    v_mul_f32 v188, v148, v188
    v_mul_f32 v189, v149, v189
    v_mul_f32 v190, v150, v190
    v_mul_f32 v191, v151, v191
    v_exp_f32 v184, v184
    v_exp_f32 v185, v185
    v_exp_f32 v186, v186
    v_exp_f32 v187, v187
    v_exp_f32 v188, v188
    v_exp_f32 v189, v189
    v_exp_f32 v190, v190
    v_exp_f32 v191, v191
    v_fma_f32 v184, v184, v229, v229
    v_fma_f32 v185, v185, v229, v229
    v_fma_f32 v186, v186, v229, v229
    v_fma_f32 v187, v187, v229, v229
    v_fma_f32 v188, v188, v229, v229
    v_fma_f32 v189, v189, v229, v229
    v_fma_f32 v190, v190, v229, v229
    v_fma_f32 v191, v191, v229, v229
    v_rcp_f32 v184, v184
    v_rcp_f32 v185, v185
    v_rcp_f32 v186, v186
    v_rcp_f32 v187, v187
    v_rcp_f32 v188, v188
    v_rcp_f32 v189, v189
    v_rcp_f32 v190, v190
    v_rcp_f32 v191, v191
    v_mul_f32 v144, v144, v184
    v_mul_f32 v145, v145, v185
    v_mul_f32 v146, v146, v186
    v_mul_f32 v147, v147, v187
    v_mul_f32 v148, v148, v188
    v_mul_f32 v149, v149, v189
    v_mul_f32 v150, v150, v190
    v_mul_f32 v151, v151, v191
    v_cvt_pk_bf16_f32 v180, v144, v145
    v_cvt_pk_bf16_f32 v181, v146, v147
    v_cvt_pk_bf16_f32 v182, v148, v149
    v_cvt_pk_bf16_f32 v183, v150, v151
    v_cndmask_b32 v180, 0, v180, s[98:99]
    v_cndmask_b32 v181, 0, v181, s[98:99]
    v_cndmask_b32 v182, 0, v182, s[98:99]
    v_cndmask_b32 v183, 0, v183, s[98:99]
    buffer_store_dwordx4 v[180:183], v221, s[52:55], s12 offen offset:1024 sc1
    s_add_u32 s15, s24, 2555904
    s_waitcnt vmcnt(0)
    v_cmp_ne_u32 vcc, 0, v25
    s_cbranch_vccnz non_1_ok
    s_mov_b32 s14, 0
non_1:
    s_sleep 1
    buffer_load_dwordx2 v[24:25], v3, s[60:63], 0 offen sc1
    s_add_u32 s14, s14, 1
    s_cmp_gt_u32 s14, 0x8000
    s_cbranch_scc1 non_1_ok
    s_waitcnt vmcnt(0)
    v_cmp_ne_u32 vcc, 0, v25
    s_cbranch_vccz non_1
non_1_ok:

    buffer_store_dwordx2 v[24:25], v19, s[52:55], s15 offen sc1
    s_mul_i32 s12, s3, 18
    s_lshl_b32 s13, s26, 2
    s_add_u32 s13, s13, s12
    s_sub_u32 s20, s13, 72
    s_cmp_ge_u32 s13, 72
    s_cselect_b32 s13, s20, s13
    s_mul_i32 s20, s13, 9216
    s_add_u32 s20, s20, s100

    s_add_u32 s21, s100, 663552
    s_lshl_b32 s12, s12, 10
    s_add_u32 m0, s12, 73728
    s_nop 0
    buffer_load_dwordx4 v4, s[40:43], s20 offen lds
    v_bfe_u32 v29, v0, 1, 3
    s_add_u32 m0, m0, 1024
    s_add_u32 s20, s20, 9216
    buffer_load_dwordx4 v4, s[40:43], s20 offen lds
    v_add_u32 v29, s4, v29
    s_add_u32 m0, m0, 1024
    s_add_u32 s20, s20, 9216
    s_cmp_eq_u32 s20, s21
    s_cselect_b32 s20, s100, s20
    buffer_load_dwordx4 v4, s[40:43], s20 offen lds
    v_add_u32 v29, 1, v29
    s_add_u32 m0, m0, 1024
    s_add_u32 s20, s20, 9216
    buffer_load_dwordx4 v4, s[40:43], s20 offen lds
    v_and_b32 v29, 7, v29
    s_add_u32 m0, m0, 1024
    s_add_u32 s20, s20, 9216
    s_cmp_eq_u32 s20, s21
    s_cselect_b32 s20, s100, s20
    buffer_load_dwordx4 v4, s[40:43], s20 offen lds
    v_and_b32 v30, 1, v0
    s_add_u32 m0, m0, 1024
    s_add_u32 s20, s20, 9216
    buffer_load_dwordx4 v4, s[40:43], s20 offen lds
    v_lshl_add_u32 v29, v29, 1, v30
    s_add_u32 m0, m0, 1024
    s_add_u32 s20, s20, 9216
    s_cmp_eq_u32 s20, s21
    s_cselect_b32 s20, s100, s20
    buffer_load_dwordx4 v4, s[40:43], s20 offen lds
    v_mul_u32_u24 v68, 9216, v1
    s_add_u32 m0, m0, 1024
    s_add_u32 s20, s20, 9216
    buffer_load_dwordx4 v4, s[40:43], s20 offen lds
    v_lshl_add_u32 v68, v29, 4, v68
    s_add_u32 m0, m0, 1024
    s_add_u32 s20, s20, 9216
    s_cmp_eq_u32 s20, s21
    s_cselect_b32 s20, s100, s20
    buffer_load_dwordx4 v4, s[40:43], s20 offen lds
    s_lshl_b32 s28, s8, 8
    s_add_u32 m0, m0, 1024
    s_add_u32 s20, s20, 9216
    buffer_load_dwordx4 v4, s[40:43], s20 offen lds
    v_add_u32 v68, s28, v68
    s_add_u32 m0, m0, 1024
    s_add_u32 s20, s20, 9216
    s_cmp_eq_u32 s20, s21
    s_cselect_b32 s20, s100, s20
    buffer_load_dwordx4 v4, s[40:43], s20 offen lds
    v_add_u32 v69, 96, v68
    s_add_u32 m0, m0, 1024
    s_add_u32 s20, s20, 9216
    buffer_load_dwordx4 v4, s[40:43], s20 offen lds
    v_add_u32 v70, 192, v68
    s_add_u32 m0, m0, 1024
    s_add_u32 s20, s20, 9216
    s_cmp_eq_u32 s20, s21
    s_cselect_b32 s20, s100, s20
    buffer_load_dwordx4 v4, s[40:43], s20 offen lds
    v_add_u32 v71, 288, v68
    s_add_u32 m0, m0, 1024
    s_add_u32 s20, s20, 9216
    buffer_load_dwordx4 v4, s[40:43], s20 offen lds
    v_subrev_u32 v72, 147456, v13
    s_add_u32 m0, m0, 1024
    s_add_u32 s20, s20, 9216
    s_cmp_eq_u32 s20, s21
    s_cselect_b32 s20, s100, s20
    buffer_load_dwordx4 v4, s[40:43], s20 offen lds
    v_add_u32 v73, 0x10000, v72
    s_add_u32 m0, m0, 1024
    s_add_u32 s20, s20, 9216
    buffer_load_dwordx4 v4, s[40:43], s20 offen lds
    v_add_u32 v74, 0x20000, v72
    s_add_u32 m0, m0, 1024
    s_add_u32 s20, s20, 9216
    s_cmp_eq_u32 s20, s21
    s_cselect_b32 s20, s100, s20
    buffer_load_dwordx4 v4, s[40:43], s20 offen lds
    v_mov_b32 v75, 0
    s_add_u32 m0, m0, 1024
    s_add_u32 s20, s20, 9216
    buffer_load_dwordx4 v4, s[40:43], s20 offen lds
    v_mov_b32 v76, 0
    v_lshrrev_b32 v29, 3, v0
    v_and_b32 v30, 6, v29
    v_and_b32 v31, 7, v0
    v_xor_b32 v30, v30, v31
    v_lshlrev_b32 v30, 2, v30
    v_mov_b32 v31, 0x75643120
    v_lshrrev_b32 v30, v30, v31
    v_and_b32 v30, 7, v30

    v_mul_u32_u24 v4, 9216, v29
    v_lshl_add_u32 v4, v30, 4, v4
    s_barrier
    ds_read_b64_tr_b16 a[192:193], v13 offset:0
    ds_read_b64_tr_b16 a[194:195], v13 offset:256
    ds_read_b64_tr_b16 a[196:197], v13 offset:1024
    ds_read_b64_tr_b16 a[198:199], v13 offset:1280
L_bstage:
    v_add_u32 v14, 73728, v6
    v_add_u32 v252, 110592, v6
    v_add_u32 v15, 73728, v7
    v_add_u32 v253, 110592, v7
    v_add_u32 v16, 73728, v8
    v_add_u32 v254, 110592, v8
    v_add_u32 v17, 73728, v9
    v_add_u32 v255, 110592, v9
    s_lshl_b32 s12, s6, 2
    s_add_u32 s12, s12, s3
    s_mul_i32 s27, s12, 18432
    s_add_u32 s27, s27, 0
    s_lshl_b32 s26, s26, 10
    s_add_u32 s26, s26, s27
    s_add_u32 s31, s27, 18432

    s_waitcnt vmcnt(0)
    s_barrier
    buffer_load_dwordx2 v[20:21], v22, s[52:55], 0 offen offset:0 sc1
    s_waitcnt vmcnt(0)
    v_cmp_ne_u64 vcc, v[20:21], v[24:25]
    s_and_b32 s12, vcc_lo, 0x3ffff
    s_cbranch_scc0 poll_2_ok
    s_mov_b32 s14, 0
poll_2:
    s_sleep 2
    buffer_load_dwordx2 v[20:21], v22, s[52:55], 0 offen offset:0 sc1
    s_add_u32 s14, s14, 1
    s_cmp_gt_u32 s14, 0x8000
    s_cbranch_scc1 poll_2_ok
    s_waitcnt vmcnt(0)
    v_cmp_ne_u64 vcc, v[20:21], v[24:25]
    s_and_b32 s12, vcc_lo, 0x3ffff
    s_cbranch_scc1 poll_2
poll_2_ok:

    buffer_load_dwordx4 a[0:3], v10, s[52:55], s26 offen offset:0 sc1
    buffer_load_dwordx4 a[4:7], v10, s[52:55], s26 offen offset:1024 sc1
    s_add_u32 s26, s26, 2048
    s_cmp_eq_u32 s26, s31
    s_cselect_b32 s26, s27, s26
    buffer_load_dwordx4 a[8:11], v10, s[52:55], s26 offen offset:0 sc1
    buffer_load_dwordx4 a[12:15], v10, s[52:55], s26 offen offset:1024 sc1
    s_add_u32 s26, s26, 2048
    s_cmp_eq_u32 s26, s31
    s_cselect_b32 s26, s27, s26
    buffer_load_dwordx4 a[16:19], v10, s[52:55], s26 offen offset:0 sc1
    buffer_load_dwordx4 a[20:23], v10, s[52:55], s26 offen offset:1024 sc1
    s_add_u32 s26, s26, 2048
    s_cmp_eq_u32 s26, s31
    s_cselect_b32 s26, s27, s26
    buffer_load_dwordx4 a[24:27], v10, s[52:55], s26 offen offset:0 sc1
    buffer_load_dwordx4 a[28:31], v10, s[52:55], s26 offen offset:1024 sc1
    s_add_u32 s26, s26, 2048
    s_cmp_eq_u32 s26, s31
    s_cselect_b32 s26, s27, s26
    s_waitcnt lgkmcnt(0)
    ds_read_b64_tr_b16 v[112:113], v14 offset:0
    ds_read_b64_tr_b16 v[114:115], v14 offset:1024
    ds_read_b64_tr_b16 v[116:117], v15 offset:0
    ds_read_b64_tr_b16 v[118:119], v15 offset:1024
    ds_read_b64_tr_b16 v[120:121], v16 offset:0
    ds_read_b64_tr_b16 v[122:123], v16 offset:1024
    ds_read_b64_tr_b16 v[124:125], v17 offset:0
    ds_read_b64_tr_b16 v[126:127], v17 offset:1024
    ds_read_b64_tr_b16 v[128:129], v14 offset:4096
    ds_read_b64_tr_b16 v[130:131], v14 offset:5120
    ds_read_b64_tr_b16 v[132:133], v15 offset:4096
    ds_read_b64_tr_b16 v[134:135], v15 offset:5120
    s_waitcnt lgkmcnt(10)
    s_waitcnt vmcnt(7)
    v_mfma_f32_16x16x32_bf16 v[136:139], v[112:115], a[0:3], 0
    s_waitcnt lgkmcnt(4)
    ds_read_b64_tr_b16 v[104:105], v16 offset:4096
    ds_read_b64_tr_b16 v[106:107], v16 offset:5120
    buffer_load_dwordx4 a[32:35], v10, s[52:55], s26 offen offset:0 sc1
    buffer_load_dwordx4 a[36:39], v10, s[52:55], s26 offen offset:1024 sc1
    s_add_u32 s26, s26, 2048
    s_cmp_eq_u32 s26, s31
    s_cselect_b32 s26, s27, s26
    v_mfma_f32_16x16x32_bf16 v[140:143], v[116:119], a[0:3], 0
    ds_read_b64_tr_b16 v[108:109], v17 offset:4096
    ds_read_b64_tr_b16 v[110:111], v17 offset:5120
    v_mfma_f32_16x16x32_bf16 v[144:147], v[120:123], a[0:3], 0
    ds_read_b64_tr_b16 v[112:113], v14 offset:8192
    ds_read_b64_tr_b16 v[114:115], v14 offset:9216
    v_mfma_f32_16x16x32_bf16 v[148:151], v[124:127], a[0:3], 0
    s_waitcnt lgkmcnt(4)
    s_waitcnt vmcnt(8)
    ds_read_b64_tr_b16 v[116:117], v15 offset:8192
    ds_read_b64_tr_b16 v[118:119], v15 offset:9216
    v_mfma_f32_16x16x32_bf16 v[136:139], v[128:131], a[4:7], v[136:139]
    ds_read_b64_tr_b16 v[120:121], v16 offset:8192
    ds_read_b64_tr_b16 v[122:123], v16 offset:9216
    v_mfma_f32_16x16x32_bf16 v[140:143], v[132:135], a[4:7], v[140:143]
    ds_read_b64_tr_b16 v[124:125], v17 offset:8192
    ds_read_b64_tr_b16 v[126:127], v17 offset:9216
    v_mfma_f32_16x16x32_bf16 v[144:147], v[104:107], a[4:7], v[144:147]
    s_waitcnt lgkmcnt(4)
    ds_read_b64_tr_b16 v[128:129], v14 offset:12288
    ds_read_b64_tr_b16 v[130:131], v14 offset:13312
    v_mfma_f32_16x16x32_bf16 v[148:151], v[108:111], a[4:7], v[148:151]
    s_waitcnt vmcnt(7)
    ds_read_b64_tr_b16 v[132:133], v15 offset:12288
    ds_read_b64_tr_b16 v[134:135], v15 offset:13312
    v_mfma_f32_16x16x32_bf16 v[136:139], v[112:115], a[8:11], v[136:139]
    ds_read_b64_tr_b16 v[104:105], v16 offset:12288
    ds_read_b64_tr_b16 v[106:107], v16 offset:13312
    buffer_load_dwordx4 a[40:43], v10, s[52:55], s26 offen offset:0 sc1
    buffer_load_dwordx4 a[44:47], v10, s[52:55], s26 offen offset:1024 sc1
    s_add_u32 s26, s26, 2048
    s_cmp_eq_u32 s26, s31
    s_cselect_b32 s26, s27, s26
    v_mfma_f32_16x16x32_bf16 v[140:143], v[116:119], a[8:11], v[140:143]
    s_waitcnt lgkmcnt(4)
    ds_read_b64_tr_b16 v[108:109], v17 offset:12288
    ds_read_b64_tr_b16 v[110:111], v17 offset:13312
    v_mfma_f32_16x16x32_bf16 v[144:147], v[120:123], a[8:11], v[144:147]
    ds_read_b64_tr_b16 v[112:113], v14 offset:16384
    ds_read_b64_tr_b16 v[114:115], v14 offset:17408
    v_mfma_f32_16x16x32_bf16 v[148:151], v[124:127], a[8:11], v[148:151]
    s_waitcnt vmcnt(8)
    ds_read_b64_tr_b16 v[116:117], v15 offset:16384
    ds_read_b64_tr_b16 v[118:119], v15 offset:17408
    v_mfma_f32_16x16x32_bf16 v[136:139], v[128:131], a[12:15], v[136:139]
    s_waitcnt lgkmcnt(4)
    ds_read_b64_tr_b16 v[120:121], v16 offset:16384
    ds_read_b64_tr_b16 v[122:123], v16 offset:17408
    v_mfma_f32_16x16x32_bf16 v[140:143], v[132:135], a[12:15], v[140:143]
    ds_read_b64_tr_b16 v[124:125], v17 offset:16384
    ds_read_b64_tr_b16 v[126:127], v17 offset:17408
    v_mfma_f32_16x16x32_bf16 v[144:147], v[104:107], a[12:15], v[144:147]
    ds_read_b64_tr_b16 v[128:129], v14 offset:20480
    ds_read_b64_tr_b16 v[130:131], v14 offset:21504
    v_mfma_f32_16x16x32_bf16 v[148:151], v[108:111], a[12:15], v[148:151]
    s_waitcnt lgkmcnt(4)
    s_waitcnt vmcnt(7)
    ds_read_b64_tr_b16 v[132:133], v15 offset:20480
    ds_read_b64_tr_b16 v[134:135], v15 offset:21504
    v_mfma_f32_16x16x32_bf16 v[136:139], v[112:115], a[16:19], v[136:139]
    ds_read_b64_tr_b16 v[104:105], v16 offset:20480
    ds_read_b64_tr_b16 v[106:107], v16 offset:21504
    buffer_load_dwordx4 a[48:51], v10, s[52:55], s26 offen offset:0 sc1
    buffer_load_dwordx4 a[52:55], v10, s[52:55], s26 offen offset:1024 sc1
    s_add_u32 s26, s26, 2048
    s_cmp_eq_u32 s26, s31
    s_cselect_b32 s26, s27, s26
    v_mfma_f32_16x16x32_bf16 v[140:143], v[116:119], a[16:19], v[140:143]
    ds_read_b64_tr_b16 v[108:109], v17 offset:20480
    ds_read_b64_tr_b16 v[110:111], v17 offset:21504
    v_mfma_f32_16x16x32_bf16 v[144:147], v[120:123], a[16:19], v[144:147]
    s_waitcnt lgkmcnt(4)
    ds_read_b64_tr_b16 v[112:113], v14 offset:24576
    ds_read_b64_tr_b16 v[114:115], v14 offset:25600
    v_mfma_f32_16x16x32_bf16 v[148:151], v[124:127], a[16:19], v[148:151]
    s_waitcnt vmcnt(8)
    ds_read_b64_tr_b16 v[116:117], v15 offset:24576
    ds_read_b64_tr_b16 v[118:119], v15 offset:25600
    v_mfma_f32_16x16x32_bf16 v[136:139], v[128:131], a[20:23], v[136:139]
    ds_read_b64_tr_b16 v[120:121], v16 offset:24576
    ds_read_b64_tr_b16 v[122:123], v16 offset:25600
    v_mfma_f32_16x16x32_bf16 v[140:143], v[132:135], a[20:23], v[140:143]
    s_waitcnt lgkmcnt(4)
    ds_read_b64_tr_b16 v[124:125], v17 offset:24576
    ds_read_b64_tr_b16 v[126:127], v17 offset:25600
    v_mfma_f32_16x16x32_bf16 v[144:147], v[104:107], a[20:23], v[144:147]
    ds_read_b64_tr_b16 v[128:129], v14 offset:28672
    ds_read_b64_tr_b16 v[130:131], v14 offset:29696
    v_mfma_f32_16x16x32_bf16 v[148:151], v[108:111], a[20:23], v[148:151]
    s_waitcnt vmcnt(7)
    ds_read_b64_tr_b16 v[132:133], v15 offset:28672
    ds_read_b64_tr_b16 v[134:135], v15 offset:29696
    v_mfma_f32_16x16x32_bf16 v[136:139], v[112:115], a[24:27], v[136:139]
    s_waitcnt lgkmcnt(4)
    ds_read_b64_tr_b16 v[104:105], v16 offset:28672
    ds_read_b64_tr_b16 v[106:107], v16 offset:29696
    buffer_load_dwordx4 a[56:59], v10, s[52:55], s26 offen offset:0 sc1
    buffer_load_dwordx4 a[60:63], v10, s[52:55], s26 offen offset:1024 sc1
    s_add_u32 s26, s26, 2048
    s_cmp_eq_u32 s26, s31
    s_cselect_b32 s26, s27, s26
    v_mfma_f32_16x16x32_bf16 v[140:143], v[116:119], a[24:27], v[140:143]
    ds_read_b64_tr_b16 v[108:109], v17 offset:28672
    ds_read_b64_tr_b16 v[110:111], v17 offset:29696
    v_mfma_f32_16x16x32_bf16 v[144:147], v[120:123], a[24:27], v[144:147]
    ds_read_b64_tr_b16 v[112:113], v14 offset:32768
    ds_read_b64_tr_b16 v[114:115], v14 offset:33792
    v_mfma_f32_16x16x32_bf16 v[148:151], v[124:127], a[24:27], v[148:151]
    s_waitcnt lgkmcnt(4)
    s_waitcnt vmcnt(8)
    ds_read_b64_tr_b16 v[116:117], v15 offset:32768
    ds_read_b64_tr_b16 v[118:119], v15 offset:33792
    v_mfma_f32_16x16x32_bf16 v[136:139], v[128:131], a[28:31], v[136:139]
    ds_read_b64_tr_b16 v[120:121], v16 offset:32768
    ds_read_b64_tr_b16 v[122:123], v16 offset:33792
    v_mfma_f32_16x16x32_bf16 v[140:143], v[132:135], a[28:31], v[140:143]
    ds_read_b64_tr_b16 v[124:125], v17 offset:32768
    ds_read_b64_tr_b16 v[126:127], v17 offset:33792
    v_mfma_f32_16x16x32_bf16 v[144:147], v[104:107], a[28:31], v[144:147]
    s_waitcnt lgkmcnt(4)
    v_mfma_f32_16x16x32_bf16 v[148:151], v[108:111], a[28:31], v[148:151]
    s_waitcnt vmcnt(7)
    v_mfma_f32_16x16x32_bf16 v[136:139], v[112:115], a[32:35], v[136:139]
    buffer_load_dwordx4 a[64:67], v10, s[52:55], s26 offen offset:0 sc1
    buffer_load_dwordx4 a[68:71], v10, s[52:55], s26 offen offset:1024 sc1
    v_mfma_f32_16x16x32_bf16 v[140:143], v[116:119], a[32:35], v[140:143]
    s_waitcnt lgkmcnt(0)
    v_mfma_f32_16x16x32_bf16 v[144:147], v[120:123], a[32:35], v[144:147]
    v_mfma_f32_16x16x32_bf16 v[148:151], v[124:127], a[32:35], v[148:151]
    s_barrier
    ds_read_b64_tr_b16 v[128:129], v252 offset:0
    ds_read_b64_tr_b16 v[130:131], v252 offset:1024
    ds_read_b64_tr_b16 v[132:133], v253 offset:0
    ds_read_b64_tr_b16 v[134:135], v253 offset:1024
    ds_read_b64_tr_b16 v[104:105], v254 offset:0
    ds_read_b64_tr_b16 v[106:107], v254 offset:1024
    ds_read_b64_tr_b16 v[108:109], v255 offset:0
    ds_read_b64_tr_b16 v[110:111], v255 offset:1024
    ds_read_b64_tr_b16 v[112:113], v252 offset:4096
    ds_read_b64_tr_b16 v[114:115], v252 offset:5120
    ds_read_b64_tr_b16 v[116:117], v253 offset:4096
    ds_read_b64_tr_b16 v[118:119], v253 offset:5120
    s_waitcnt lgkmcnt(10)
    s_waitcnt vmcnt(8)
    v_mfma_f32_16x16x32_bf16 v[136:139], v[128:131], a[36:39], v[136:139]
    s_waitcnt lgkmcnt(4)
    ds_read_b64_tr_b16 v[120:121], v254 offset:4096
    ds_read_b64_tr_b16 v[122:123], v254 offset:5120
    v_mfma_f32_16x16x32_bf16 v[140:143], v[132:135], a[36:39], v[140:143]
    ds_read_b64_tr_b16 v[124:125], v255 offset:4096
    ds_read_b64_tr_b16 v[126:127], v255 offset:5120
    v_mfma_f32_16x16x32_bf16 v[144:147], v[104:107], a[36:39], v[144:147]
    ds_read_b64_tr_b16 v[128:129], v252 offset:8192
    ds_read_b64_tr_b16 v[130:131], v252 offset:9216
    s_mul_i32 s12, s3, 9
    s_add_u32 s12, s12, 0
    s_lshl_b32 s13, s18, 2
    s_add_u32 s13, s13, s12
    s_sub_u32 s20, s13, 72
    s_cmp_ge_u32 s13, 72
    s_cselect_b32 s13, s20, s13
    s_mul_i32 s20, s13, 73728
    s_lshl_b32 s12, s12, 10
    s_add_u32 m0, s12, 0
    s_add_u32 s20, s20, s17
    s_add_u32 s21, s17, 5308416

    buffer_load_dwordx4 v4, s[44:47], s20 offen lds
    v_mfma_f32_16x16x32_bf16 v[148:151], v[108:111], a[36:39], v[148:151]
    s_waitcnt lgkmcnt(4)
    s_waitcnt vmcnt(8)
    ds_read_b64_tr_b16 v[132:133], v253 offset:8192
    ds_read_b64_tr_b16 v[134:135], v253 offset:9216
    s_add_u32 m0, m0, 1024
    s_add_u32 s20, s20, 73728
    s_cmp_eq_u32 s20, s21
    s_cselect_b32 s20, s17, s20
    buffer_load_dwordx4 v4, s[44:47], s20 offen lds
    v_mfma_f32_16x16x32_bf16 v[136:139], v[112:115], a[40:43], v[136:139]
    ds_read_b64_tr_b16 v[104:105], v254 offset:8192
    ds_read_b64_tr_b16 v[106:107], v254 offset:9216
    v_mfma_f32_16x16x32_bf16 v[140:143], v[116:119], a[40:43], v[140:143]
    ds_read_b64_tr_b16 v[108:109], v255 offset:8192
    ds_read_b64_tr_b16 v[110:111], v255 offset:9216
    s_add_u32 m0, m0, 1024
    s_add_u32 s20, s20, 73728
    s_cmp_eq_u32 s20, s21
    s_cselect_b32 s20, s17, s20
    buffer_load_dwordx4 v4, s[44:47], s20 offen lds
    v_mfma_f32_16x16x32_bf16 v[144:147], v[120:123], a[40:43], v[144:147]
    s_waitcnt lgkmcnt(4)
    ds_read_b64_tr_b16 v[112:113], v252 offset:12288
    ds_read_b64_tr_b16 v[114:115], v252 offset:13312
    v_mfma_f32_16x16x32_bf16 v[148:151], v[124:127], a[40:43], v[148:151]
    s_waitcnt vmcnt(9)
    ds_read_b64_tr_b16 v[116:117], v253 offset:12288
    ds_read_b64_tr_b16 v[118:119], v253 offset:13312
    s_add_u32 m0, m0, 1024
    s_add_u32 s20, s20, 73728
    s_cmp_eq_u32 s20, s21
    s_cselect_b32 s20, s17, s20
    buffer_load_dwordx4 v4, s[44:47], s20 offen lds
    v_mfma_f32_16x16x32_bf16 v[136:139], v[128:131], a[44:47], v[136:139]
    ds_read_b64_tr_b16 v[120:121], v254 offset:12288
    ds_read_b64_tr_b16 v[122:123], v254 offset:13312
    v_mfma_f32_16x16x32_bf16 v[140:143], v[132:135], a[44:47], v[140:143]
    s_waitcnt lgkmcnt(4)
    ds_read_b64_tr_b16 v[124:125], v255 offset:12288
    ds_read_b64_tr_b16 v[126:127], v255 offset:13312
    s_add_u32 m0, m0, 1024
    s_add_u32 s20, s20, 73728
    s_cmp_eq_u32 s20, s21
    s_cselect_b32 s20, s17, s20
    buffer_load_dwordx4 v4, s[44:47], s20 offen lds
    v_mfma_f32_16x16x32_bf16 v[144:147], v[104:107], a[44:47], v[144:147]
    ds_read_b64_tr_b16 v[128:129], v252 offset:16384
    ds_read_b64_tr_b16 v[130:131], v252 offset:17408
    s_add_u32 m0, m0, 1024
    s_add_u32 s20, s20, 73728
    s_cmp_eq_u32 s20, s21
    s_cselect_b32 s20, s17, s20
    buffer_load_dwordx4 v4, s[44:47], s20 offen lds
    v_mfma_f32_16x16x32_bf16 v[148:151], v[108:111], a[44:47], v[148:151]
    s_waitcnt vmcnt(11)
    ds_read_b64_tr_b16 v[132:133], v253 offset:16384
    ds_read_b64_tr_b16 v[134:135], v253 offset:17408
    v_mfma_f32_16x16x32_bf16 v[136:139], v[112:115], a[48:51], v[136:139]
    s_waitcnt lgkmcnt(4)
    ds_read_b64_tr_b16 v[104:105], v254 offset:16384
    ds_read_b64_tr_b16 v[106:107], v254 offset:17408
    s_add_u32 m0, m0, 1024
    s_add_u32 s20, s20, 73728
    s_cmp_eq_u32 s20, s21
    s_cselect_b32 s20, s17, s20
    buffer_load_dwordx4 v4, s[44:47], s20 offen lds
    v_mfma_f32_16x16x32_bf16 v[140:143], v[116:119], a[48:51], v[140:143]
    ds_read_b64_tr_b16 v[108:109], v255 offset:16384
    ds_read_b64_tr_b16 v[110:111], v255 offset:17408
    v_mfma_f32_16x16x32_bf16 v[144:147], v[120:123], a[48:51], v[144:147]
    ds_read_b64_tr_b16 v[112:113], v252 offset:20480
    ds_read_b64_tr_b16 v[114:115], v252 offset:21504
    s_add_u32 m0, m0, 1024
    s_add_u32 s20, s20, 73728
    s_cmp_eq_u32 s20, s21
    s_cselect_b32 s20, s17, s20
    buffer_load_dwordx4 v4, s[44:47], s20 offen lds
    v_mfma_f32_16x16x32_bf16 v[148:151], v[124:127], a[48:51], v[148:151]
    s_waitcnt lgkmcnt(4)
    s_waitcnt vmcnt(12)
    ds_read_b64_tr_b16 v[116:117], v253 offset:20480
    ds_read_b64_tr_b16 v[118:119], v253 offset:21504
    v_mfma_f32_16x16x32_bf16 v[136:139], v[128:131], a[52:55], v[136:139]
    ds_read_b64_tr_b16 v[120:121], v254 offset:20480
    ds_read_b64_tr_b16 v[122:123], v254 offset:21504
    s_add_u32 m0, m0, 1024
    s_add_u32 s20, s20, 73728
    s_cmp_eq_u32 s20, s21
    s_cselect_b32 s20, s17, s20
    buffer_load_dwordx4 v4, s[44:47], s20 offen lds
    v_mfma_f32_16x16x32_bf16 v[140:143], v[132:135], a[52:55], v[140:143]
    ds_read_b64_tr_b16 v[124:125], v255 offset:20480
    ds_read_b64_tr_b16 v[126:127], v255 offset:21504
    v_mfma_f32_16x16x32_bf16 v[144:147], v[104:107], a[52:55], v[144:147]
    s_waitcnt lgkmcnt(4)
    ds_read_b64_tr_b16 v[128:129], v252 offset:24576
    ds_read_b64_tr_b16 v[130:131], v252 offset:25600
    s_mul_i32 s12, s3, 9
    s_add_u32 s12, s12, 0
    s_lshl_b32 s13, s18, 2
    s_add_u32 s13, s13, s12
    s_sub_u32 s20, s13, 72
    s_cmp_ge_u32 s13, 72
    s_cselect_b32 s13, s20, s13
    s_mul_i32 s20, s13, 73728
    s_lshl_b32 s12, s12, 10
    s_add_u32 m0, s12, 73728
    s_add_u32 s20, s20, s25
    s_add_u32 s21, s25, 5308416

    buffer_load_dwordx4 v4, s[44:47], s20 offen lds
    v_mfma_f32_16x16x32_bf16 v[148:151], v[108:111], a[52:55], v[148:151]
    s_waitcnt vmcnt(13)
    ds_read_b64_tr_b16 v[132:133], v253 offset:24576
    ds_read_b64_tr_b16 v[134:135], v253 offset:25600
    s_add_u32 m0, m0, 1024
    s_add_u32 s20, s20, 73728
    s_cmp_eq_u32 s20, s21
    s_cselect_b32 s20, s25, s20
    buffer_load_dwordx4 v4, s[44:47], s20 offen lds
    v_mfma_f32_16x16x32_bf16 v[136:139], v[112:115], a[56:59], v[136:139]
    ds_read_b64_tr_b16 v[104:105], v254 offset:24576
    ds_read_b64_tr_b16 v[106:107], v254 offset:25600
    v_mfma_f32_16x16x32_bf16 v[140:143], v[116:119], a[56:59], v[140:143]
    s_waitcnt lgkmcnt(4)
    ds_read_b64_tr_b16 v[108:109], v255 offset:24576
    ds_read_b64_tr_b16 v[110:111], v255 offset:25600
    s_add_u32 m0, m0, 1024
    s_add_u32 s20, s20, 73728
    s_cmp_eq_u32 s20, s21
    s_cselect_b32 s20, s25, s20
    buffer_load_dwordx4 v4, s[44:47], s20 offen lds
    v_mfma_f32_16x16x32_bf16 v[144:147], v[120:123], a[56:59], v[144:147]
    ds_read_b64_tr_b16 v[112:113], v252 offset:28672
    ds_read_b64_tr_b16 v[114:115], v252 offset:29696
    v_mfma_f32_16x16x32_bf16 v[148:151], v[124:127], a[56:59], v[148:151]
    s_waitcnt vmcnt(14)
    ds_read_b64_tr_b16 v[116:117], v253 offset:28672
    ds_read_b64_tr_b16 v[118:119], v253 offset:29696
    s_add_u32 m0, m0, 1024
    s_add_u32 s20, s20, 73728
    s_cmp_eq_u32 s20, s21
    s_cselect_b32 s20, s25, s20
    buffer_load_dwordx4 v4, s[44:47], s20 offen lds
    v_mfma_f32_16x16x32_bf16 v[136:139], v[128:131], a[60:63], v[136:139]
    s_waitcnt lgkmcnt(4)
    ds_read_b64_tr_b16 v[120:121], v254 offset:28672
    ds_read_b64_tr_b16 v[122:123], v254 offset:29696
    v_mfma_f32_16x16x32_bf16 v[140:143], v[132:135], a[60:63], v[140:143]
    ds_read_b64_tr_b16 v[124:125], v255 offset:28672
    ds_read_b64_tr_b16 v[126:127], v255 offset:29696
    s_add_u32 m0, m0, 1024
    s_add_u32 s20, s20, 73728
    s_cmp_eq_u32 s20, s21
    s_cselect_b32 s20, s25, s20
    buffer_load_dwordx4 v4, s[44:47], s20 offen lds
    v_mfma_f32_16x16x32_bf16 v[144:147], v[104:107], a[60:63], v[144:147]
    ds_read_b64_tr_b16 v[128:129], v252 offset:32768
    ds_read_b64_tr_b16 v[130:131], v252 offset:33792
    s_add_u32 m0, m0, 1024
    s_add_u32 s20, s20, 73728
    s_cmp_eq_u32 s20, s21
    s_cselect_b32 s20, s25, s20
    buffer_load_dwordx4 v4, s[44:47], s20 offen lds
    v_mfma_f32_16x16x32_bf16 v[148:151], v[108:111], a[60:63], v[148:151]
    s_waitcnt lgkmcnt(4)
    s_waitcnt vmcnt(16)
    ds_read_b64_tr_b16 v[132:133], v253 offset:32768
    ds_read_b64_tr_b16 v[134:135], v253 offset:33792
    v_mfma_f32_16x16x32_bf16 v[136:139], v[112:115], a[64:67], v[136:139]
    ds_read_b64_tr_b16 v[104:105], v254 offset:32768
    ds_read_b64_tr_b16 v[106:107], v254 offset:33792
    s_add_u32 m0, m0, 1024
    s_add_u32 s20, s20, 73728
    s_cmp_eq_u32 s20, s21
    s_cselect_b32 s20, s25, s20
    buffer_load_dwordx4 v4, s[44:47], s20 offen lds
    v_mfma_f32_16x16x32_bf16 v[140:143], v[116:119], a[64:67], v[140:143]
    ds_read_b64_tr_b16 v[108:109], v255 offset:32768
    ds_read_b64_tr_b16 v[110:111], v255 offset:33792
    v_mfma_f32_16x16x32_bf16 v[144:147], v[120:123], a[64:67], v[144:147]
    s_waitcnt lgkmcnt(4)
    s_add_u32 m0, m0, 1024
    s_add_u32 s20, s20, 73728
    s_cmp_eq_u32 s20, s21
    s_cselect_b32 s20, s25, s20
    buffer_load_dwordx4 v4, s[44:47], s20 offen lds
    v_mfma_f32_16x16x32_bf16 v[148:151], v[124:127], a[64:67], v[148:151]
    s_waitcnt vmcnt(17)
    v_mfma_f32_16x16x32_bf16 v[136:139], v[128:131], a[68:71], v[136:139]
    s_add_u32 m0, m0, 1024
    s_add_u32 s20, s20, 73728
    s_cmp_eq_u32 s20, s21
    s_cselect_b32 s20, s25, s20
    buffer_load_dwordx4 v4, s[44:47], s20 offen lds
    v_mfma_f32_16x16x32_bf16 v[140:143], v[132:135], a[68:71], v[140:143]
    s_waitcnt lgkmcnt(0)
    v_mfma_f32_16x16x32_bf16 v[144:147], v[104:107], a[68:71], v[144:147]
    v_mfma_f32_16x16x32_bf16 v[148:151], v[108:111], a[68:71], v[148:151]
    s_and_b32 s13, s3, 1
    s_mul_i32 s13, s13, 18432
    s_add_u32 s12, s23, s13
    s_add_u32 s12, s12, 1179648
    v_mov_b32 v218, 0
    v_mov_b32 v219, 0
    s_nop 1

    v_cvt_pk_bf16_f32 v137, v136, v137
    v_lshlrev_b32 v136, 16, v137
    v_and_b32 v137, 0xffff0000, v137
    v_lshlrev_b32 v212, 16, v240
    v_and_b32 v213, 0xffff0000, v240
    v_add_f32 v136, v136, v212
    v_add_f32 v137, v137, v213
    v_cvt_pk_bf16_f32 v176, v136, v137

    v_cvt_pk_bf16_f32 v139, v138, v139
    v_lshlrev_b32 v138, 16, v139
    v_and_b32 v139, 0xffff0000, v139
    v_lshlrev_b32 v212, 16, v241
    v_and_b32 v213, 0xffff0000, v241
    v_add_f32 v138, v138, v212
    v_add_f32 v139, v139, v213
    v_cvt_pk_bf16_f32 v177, v138, v139

    v_cvt_pk_bf16_f32 v141, v140, v141
    v_lshlrev_b32 v140, 16, v141
    v_and_b32 v141, 0xffff0000, v141
    v_lshlrev_b32 v212, 16, v242
    v_and_b32 v213, 0xffff0000, v242
    v_add_f32 v140, v140, v212
    v_add_f32 v141, v141, v213
    v_cvt_pk_bf16_f32 v178, v140, v141

    v_cvt_pk_bf16_f32 v143, v142, v143
    v_lshlrev_b32 v142, 16, v143
    v_and_b32 v143, 0xffff0000, v143
    v_lshlrev_b32 v212, 16, v243
    v_and_b32 v213, 0xffff0000, v243
    v_add_f32 v142, v142, v212
    v_add_f32 v143, v143, v213
    v_cvt_pk_bf16_f32 v179, v142, v143

    buffer_store_dwordx4 v[176:179], v10, s[52:55], s12 offen offset:0 sc1
    v_cvt_pk_bf16_f32 v145, v144, v145
    v_lshlrev_b32 v144, 16, v145
    v_and_b32 v145, 0xffff0000, v145
    v_lshlrev_b32 v212, 16, v244
    v_and_b32 v213, 0xffff0000, v244
    v_add_f32 v144, v144, v212
    v_add_f32 v145, v145, v213
    v_cvt_pk_bf16_f32 v180, v144, v145

    v_cvt_pk_bf16_f32 v147, v146, v147
    v_lshlrev_b32 v146, 16, v147
    v_and_b32 v147, 0xffff0000, v147
    v_lshlrev_b32 v212, 16, v245
    v_and_b32 v213, 0xffff0000, v245
    v_add_f32 v146, v146, v212
    v_add_f32 v147, v147, v213
    v_cvt_pk_bf16_f32 v181, v146, v147

    v_cvt_pk_bf16_f32 v149, v148, v149
    v_lshlrev_b32 v148, 16, v149
    v_and_b32 v149, 0xffff0000, v149
    v_lshlrev_b32 v212, 16, v246
    v_and_b32 v213, 0xffff0000, v246
    v_add_f32 v148, v148, v212
    v_add_f32 v149, v149, v213
    v_cvt_pk_bf16_f32 v182, v148, v149

    v_cvt_pk_bf16_f32 v151, v150, v151
    v_lshlrev_b32 v150, 16, v151
    v_and_b32 v151, 0xffff0000, v151
    v_lshlrev_b32 v212, 16, v247
    v_and_b32 v213, 0xffff0000, v247
    v_add_f32 v150, v150, v212
    v_add_f32 v151, v151, v213
    v_cvt_pk_bf16_f32 v183, v150, v151

    buffer_store_dwordx4 v[180:183], v10, s[52:55], s12 offen offset:1024 sc1
    v_dot2_f32_bf16 v218, v176, v18, v218
    v_dot2_f32_bf16 v219, v176, v176, v219
    v_dot2_f32_bf16 v218, v177, v18, v218
    v_dot2_f32_bf16 v219, v177, v177, v219
    v_dot2_f32_bf16 v218, v178, v18, v218
    v_dot2_f32_bf16 v219, v178, v178, v219
    v_dot2_f32_bf16 v218, v179, v18, v218
    v_dot2_f32_bf16 v219, v179, v179, v219
    v_dot2_f32_bf16 v218, v180, v18, v218
    v_dot2_f32_bf16 v219, v180, v180, v219
    v_dot2_f32_bf16 v218, v181, v18, v218
    v_dot2_f32_bf16 v219, v181, v181, v219
    v_dot2_f32_bf16 v218, v182, v18, v218
    v_dot2_f32_bf16 v219, v182, v182, v219
    v_dot2_f32_bf16 v218, v183, v18, v218
    v_dot2_f32_bf16 v219, v183, v183, v219
    s_lshl_b32 s12, s7, 7
    s_lshl_b32 s13, s6, 2
    s_add_u32 s13, s13, s3
    s_lshl_b32 s13, s13, 11
    s_add_u32 s12, s12, s13
    s_add_u32 s12, s12, 2359296
    v_lshlrev_b32 v29, 3, v0
    v_cmp_gt_u32 vcc, 16, v0
    v_mov_b32 v30, 0x7ff00000

    v_mov_b32 v212, v218
    s_nop 1
    v_permlane16_swap_b32 v218, v212
    s_nop 1
    v_add_f32 v218, v218, v212
    v_mov_b32 v212, v218
    s_nop 1
    v_permlane32_swap_b32 v218, v212
    s_nop 1
    v_add_f32 v218, v218, v212

    v_mov_b32 v212, v219
    s_nop 1
    v_permlane16_swap_b32 v219, v212
    s_nop 1
    v_add_f32 v219, v219, v212
    v_mov_b32 v212, v219
    s_nop 1
    v_permlane32_swap_b32 v219, v212
    s_nop 1
    v_add_f32 v219, v219, v212

    v_cndmask_b32 v29, v30, v29, vcc
    buffer_store_dwordx2 v[218:219], v29, s[52:55], s12 offen sc1
    s_add_u32 s15, s24, 2564096
    s_waitcnt vmcnt(0)
    buffer_store_dwordx2 v[24:25], v19, s[52:55], s15 offen sc1
    s_barrier
    s_mul_i32 s12, s3, 9
    s_add_u32 s12, s12, 36
    s_lshl_b32 s13, s18, 2
    s_add_u32 s13, s13, s12
    s_sub_u32 s20, s13, 72
    s_cmp_ge_u32 s13, 72
    s_cselect_b32 s13, s20, s13
    s_mul_i32 s20, s13, 73728
    s_lshl_b32 s12, s12, 10
    s_add_u32 m0, s12, 0
    s_add_u32 s20, s20, s17
    s_add_u32 s21, s17, 5308416

    buffer_load_dwordx4 v4, s[44:47], s20 offen lds
    s_add_u32 m0, m0, 1024
    s_add_u32 s20, s20, 73728
    s_cmp_eq_u32 s20, s21
    s_cselect_b32 s20, s17, s20
    buffer_load_dwordx4 v4, s[44:47], s20 offen lds
    s_add_u32 m0, m0, 1024
    s_add_u32 s20, s20, 73728
    s_cmp_eq_u32 s20, s21
    s_cselect_b32 s20, s17, s20
    buffer_load_dwordx4 v4, s[44:47], s20 offen lds
    s_add_u32 m0, m0, 1024
    s_add_u32 s20, s20, 73728
    s_cmp_eq_u32 s20, s21
    s_cselect_b32 s20, s17, s20
    buffer_load_dwordx4 v4, s[44:47], s20 offen lds
    s_add_u32 m0, m0, 1024
    s_add_u32 s20, s20, 73728
    s_cmp_eq_u32 s20, s21
    s_cselect_b32 s20, s17, s20
    buffer_load_dwordx4 v4, s[44:47], s20 offen lds
    s_add_u32 m0, m0, 1024
    s_add_u32 s20, s20, 73728
    s_cmp_eq_u32 s20, s21
    s_cselect_b32 s20, s17, s20
    buffer_load_dwordx4 v4, s[44:47], s20 offen lds
    s_add_u32 m0, m0, 1024
    s_add_u32 s20, s20, 73728
    s_cmp_eq_u32 s20, s21
    s_cselect_b32 s20, s17, s20
    buffer_load_dwordx4 v4, s[44:47], s20 offen lds
    s_add_u32 m0, m0, 1024
    s_add_u32 s20, s20, 73728
    s_cmp_eq_u32 s20, s21
    s_cselect_b32 s20, s17, s20
    buffer_load_dwordx4 v4, s[44:47], s20 offen lds
    s_add_u32 m0, m0, 1024
    s_add_u32 s20, s20, 73728
    s_cmp_eq_u32 s20, s21
    s_cselect_b32 s20, s17, s20
    buffer_load_dwordx4 v4, s[44:47], s20 offen lds
    s_mul_i32 s12, s3, 9
    s_add_u32 s12, s12, 36
    s_lshl_b32 s13, s18, 2
    s_add_u32 s13, s13, s12
    s_sub_u32 s20, s13, 72
    s_cmp_ge_u32 s13, 72
    s_cselect_b32 s13, s20, s13
    s_mul_i32 s20, s13, 73728
    s_lshl_b32 s12, s12, 10
    s_add_u32 m0, s12, 73728
    s_add_u32 s20, s20, s25
    s_add_u32 s21, s25, 5308416

    buffer_load_dwordx4 v4, s[44:47], s20 offen lds
    s_add_u32 m0, m0, 1024
    s_add_u32 s20, s20, 73728
    s_cmp_eq_u32 s20, s21
    s_cselect_b32 s20, s25, s20
    buffer_load_dwordx4 v4, s[44:47], s20 offen lds
    s_add_u32 m0, m0, 1024
    s_add_u32 s20, s20, 73728
    s_cmp_eq_u32 s20, s21
    s_cselect_b32 s20, s25, s20
    buffer_load_dwordx4 v4, s[44:47], s20 offen lds
    s_add_u32 m0, m0, 1024
    s_add_u32 s20, s20, 73728
    s_cmp_eq_u32 s20, s21
    s_cselect_b32 s20, s25, s20
    buffer_load_dwordx4 v4, s[44:47], s20 offen lds
    s_add_u32 m0, m0, 1024
    s_add_u32 s20, s20, 73728
    s_cmp_eq_u32 s20, s21
    s_cselect_b32 s20, s25, s20
    buffer_load_dwordx4 v4, s[44:47], s20 offen lds
    s_add_u32 m0, m0, 1024
    s_add_u32 s20, s20, 73728
    s_cmp_eq_u32 s20, s21
    s_cselect_b32 s20, s25, s20
    buffer_load_dwordx4 v4, s[44:47], s20 offen lds
    s_add_u32 m0, m0, 1024
    s_add_u32 s20, s20, 73728
    s_cmp_eq_u32 s20, s21
    s_cselect_b32 s20, s25, s20
    buffer_load_dwordx4 v4, s[44:47], s20 offen lds
    s_add_u32 m0, m0, 1024
    s_add_u32 s20, s20, 73728
    s_cmp_eq_u32 s20, s21
    s_cselect_b32 s20, s25, s20
    buffer_load_dwordx4 v4, s[44:47], s20 offen lds
    s_add_u32 m0, m0, 1024
    s_add_u32 s20, s20, 73728
    s_cmp_eq_u32 s20, s21
    s_cselect_b32 s20, s25, s20
    buffer_load_dwordx4 v4, s[44:47], s20 offen lds
    s_branch L_cstart2
L_idle:
    s_and_b32 s101, s2, 7
    s_sub_u32 s12, s5, 18
    s_and_b32 s13, s12, 3
    s_lshl_b32 s13, s13, 2
    s_add_u32 s13, s13, s3
    s_mul_i32 s13, s13, 36
    v_lshrrev_b32 v29, 3, v0
    v_and_b32 v30, 7, v0
    v_lshrrev_b32 v31, 1, v30
    v_mul_u32_u24 v31, 18432, v31
    v_and_b32 v166, 1, v0
    v_lshl_add_u32 v31, v166, 4, v31
    v_lshlrev_b32 v30, 4, v30
    s_mul_i32 s14, s101, 73728
    s_cmp_ge_u32 s12, 4
    s_cselect_b32 s96, 1152, s30
    s_cselect_b32 s97, 32047104, s30
    s_cbranch_scc1 L_rp4
    s_movk_i32 s96, 9216
    s_mov_b32 s97, 31457280
L_rp4:
    s_add_u32 s97, s97, s14

    v_add_u32 v167, 0, v29
    v_min_u32 v167, 35, v167
    v_add_u32 v167, s13, v167
    v_lshl_add_u32 v156, v167, 5, v31
    v_mul_lo_u32 v167, v167, s96
    v_add_u32 v161, v167, v30

    v_add_u32 v167, 8, v29
    v_min_u32 v167, 35, v167
    v_add_u32 v167, s13, v167
    v_lshl_add_u32 v157, v167, 5, v31
    v_mul_lo_u32 v167, v167, s96
    v_add_u32 v162, v167, v30

    v_add_u32 v167, 16, v29
    v_min_u32 v167, 35, v167
    v_add_u32 v167, s13, v167
    v_lshl_add_u32 v158, v167, 5, v31
    v_mul_lo_u32 v167, v167, s96
    v_add_u32 v163, v167, v30

    v_add_u32 v167, 24, v29
    v_min_u32 v167, 35, v167
    v_add_u32 v167, s13, v167
    v_lshl_add_u32 v159, v167, 5, v31
    v_mul_lo_u32 v167, v167, s96
    v_add_u32 v164, v167, v30

    v_add_u32 v167, 32, v29
    v_min_u32 v167, 35, v167
    v_add_u32 v167, s13, v167
    v_lshl_add_u32 v160, v167, 5, v31
    v_mul_lo_u32 v167, v167, s96
    v_add_u32 v165, v167, v30

    s_mov_b32 s99, s97
    s_cmp_ge_u32 s12, 8
    s_cbranch_scc1 L_norp
    s_cmp_ge_u32 s12, 4
    s_cbranch_scc1 L_rp4b
    s_mul_i32 s14, s101, 1152

    buffer_load_dwordx4 v[136:139], v161, s[44:47], s14 offen offset:1024
    buffer_load_dwordx4 v[140:143], v162, s[44:47], s14 offen offset:1024
    buffer_load_dwordx4 v[144:147], v163, s[44:47], s14 offen offset:1024
    buffer_load_dwordx4 v[148:151], v164, s[44:47], s14 offen offset:1024
    buffer_load_dwordx4 v[152:155], v165, s[44:47], s14 offen offset:1024
    s_branch L_rpc
L_rp4b:
    s_mul_i32 s14, s101, 663552
    buffer_load_dwordx4 v[136:139], v161, s[48:51], s14 offen offset:1024
    buffer_load_dwordx4 v[140:143], v162, s[48:51], s14 offen offset:1024
    buffer_load_dwordx4 v[144:147], v163, s[48:51], s14 offen offset:1024
    buffer_load_dwordx4 v[148:151], v164, s[48:51], s14 offen offset:1024
    buffer_load_dwordx4 v[152:155], v165, s[48:51], s14 offen offset:1024
L_rpc:
L_norp:
    v_lshrrev_b32 v29, 3, v0
    v_and_b32 v30, 6, v29
    v_and_b32 v31, 7, v0
    v_xor_b32 v30, v30, v31
    v_lshlrev_b32 v30, 2, v30
    v_mov_b32 v31, 0x75643120
    v_lshrrev_b32 v30, v30, v31
    v_and_b32 v30, 7, v30

    v_mul_u32_u24 v4, 9216, v29
    v_lshl_add_u32 v4, v30, 4, v4
    s_lshl_b32 s12, s9, 3
    s_lshl_b32 s13, s3, 1
    s_add_u32 s19, s12, s13
    v_add_u32 v11, 18432, v10
    v_bfe_u32 v29, v0, 1, 3
    v_add_u32 v29, s4, v29
    v_add_u32 v29, 1, v29
    v_and_b32 v29, 7, v29
    v_and_b32 v30, 1, v0
    v_lshl_add_u32 v29, v29, 1, v30
    v_mul_u32_u24 v68, 9216, v1
    v_lshl_add_u32 v68, v29, 4, v68
    s_lshl_b32 s28, s8, 8
    v_add_u32 v68, s28, v68
    v_add_u32 v69, 96, v68
    v_add_u32 v70, 192, v68
    v_add_u32 v71, 288, v68
    v_subrev_u32 v72, 147456, v13
    v_add_u32 v73, 0x10000, v72
    v_add_u32 v74, 0x20000, v72
    v_mov_b32 v75, 0
    v_mov_b32 v76, 0
    s_mul_i32 s0, s4, 663552
    s_lshl_b32 s12, s19, 3
    s_add_u32 s12, s12, s4
    s_mul_i32 s1, s12, 18432
    s_add_u32 s1, s1, 3145728
    v_and_b32 v29, 1, v1
    v_lshlrev_b32 v23, 8, v29
    v_lshl_add_u32 v23, v2, 4, v23
    v_lshrrev_b32 v29, 1, v1
    v_lshl_add_u32 v23, v29, 3, v23
    v_add_u32 v12, 147456, v10
    s_lshl_b32 s12, s9, 3
    s_add_u32 s12, s12, s4
    s_lshl_b32 s12, s12, 2
    s_add_u32 s12, s12, s3
    s_lshl_b32 s12, s12, 10
    s_add_u32 s10, s12, 2621440
    s_lshl_b32 s12, s8, 3
    s_add_u32 s22, s10, s12
    s_lshl_b32 s12, s19, 11
    s_add_u32 s12, s12, 2359296
    v_mul_u32_u24 v80, 384, v1
    v_lshl_add_u32 v80, v2, 3, v80
    v_add_u32 v80, s12, v80
    v_mov_b32 v31, 0x7ff00000
    v_cmp_gt_u32 vcc, 48, v0
    s_lshl_b32 s13, s16, 10
    s_add_u32 s13, s13, 2490368
    v_cndmask_b32 v80, v31, v80, vcc
    v_lshlrev_b32 v81, 3, v2
    v_add_u32 v81, s13, v81
    s_lshl_b32 s12, s9, 2
    s_add_u32 s12, s12, s8
    s_mul_i32 s12, s12, 589824
    s_add_u32 s11, s12, 12582912
    s_lshl_b32 s12, s4, 12
    s_lshl_b32 s13, s3, 10
    s_add_u32 s12, s12, s13
    s_add_u32 s12, s12, s11
    v_add_u32 v78, s12, v10
    s_lshl_b32 s12, s4, 3
    s_lshl_b32 s13, s3, 6
    s_add_u32 s12, s12, s13
    s_add_u32 s12, s12, s11
    s_add_u32 s12, s12, 32768
    v_add_u32 v79, s12, v19
    v_mul_u32_u24 v77, 1152, v2
    v_lshl_add_u32 v77, v1, 3, v77
    s_add_u32 s12, s8, 0
    s_and_b32 s12, s12, 3
    s_lshl_b32 s88, s12, 2
    s_lshl_b32 s12, s12, 12
    s_add_u32 s92, s12, s1
    s_add_u32 s12, s8, 1
    s_and_b32 s12, s12, 3
    s_lshl_b32 s89, s12, 2
    s_lshl_b32 s12, s12, 12
    s_add_u32 s93, s12, s1
    s_add_u32 s12, s8, 2
    s_and_b32 s12, s12, 3
    s_lshl_b32 s90, s12, 2
    s_lshl_b32 s12, s12, 12
    s_add_u32 s94, s12, s1
    s_add_u32 s12, s8, 3
    s_and_b32 s12, s12, 3
    s_lshl_b32 s91, s12, 2
    s_lshl_b32 s12, s12, 12
    s_add_u32 s95, s12, s1
    v_mov_b32 v60, 0
    v_mov_b32 v61, 0
    v_mov_b32 v62, 0
    v_mov_b32 v63, 0
    v_mov_b32 v64, 0
    v_mov_b32 v65, 0
    v_mov_b32 v66, 0
    v_mov_b32 v67, 0
    s_cmp_ge_u32 s5, 26
    s_cbranch_scc1 L_norp2
    s_waitcnt vmcnt(0)
    buffer_store_dwordx4 v[136:139], v156, s[52:55], s99 offen sc1
    buffer_store_dwordx4 v[140:143], v157, s[52:55], s99 offen sc1
    buffer_store_dwordx4 v[144:147], v158, s[52:55], s99 offen sc1
    buffer_store_dwordx4 v[148:151], v159, s[52:55], s99 offen sc1
    buffer_store_dwordx4 v[152:155], v160, s[52:55], s99 offen sc1
L_norp2:
    v_lshlrev_b32 v29, 21, v2
    v_add_u32 v29, 0x1ff000, v29
    s_lshl_b32 s12, s9, 2
    s_add_u32 s12, s12, s3
    s_lshl_b32 s12, s12, 8
    s_add_u32 s12, s12, 2564096
    v_writelane_b32 v29, s12, 0
    s_add_u32 s12, s12, 128
    v_writelane_b32 v29, s12, 1
    s_lshl_b32 s13, s16, 6
    s_add_u32 s13, s13, 2572288
    v_writelane_b32 v29, s13, 2
    v_writelane_b32 v29, s10, 3
    s_add_u32 s12, s10, 128
    v_writelane_b32 v29, s12, 4
    s_add_u32 s12, s12, 128
    v_writelane_b32 v29, s12, 7
    s_add_u32 s12, s12, 128
    v_writelane_b32 v29, s12, 8
    s_lshl_b32 s12, s4, 16
    s_lshl_b32 s13, s3, 6
    s_add_u32 s12, s12, s13
    s_add_u32 s12, s12, s11
    s_add_u32 s12, s12, 32768
    v_writelane_b32 v29, s12, 5
    s_lshr_b32 s13, s4, 1
    s_lshl_b32 s13, s13, 6
    s_add_u32 s12, s13, s11
    s_add_u32 s12, s12, 557056
    v_writelane_b32 v29, s12, 6

    buffer_load_dword v249, v29, s[52:55], 0 offen sc1
    buffer_load_dword v248, v19, s[56:59], 0 offen
    s_add_u32 s12, s3, 0
    s_min_u32 s12, s12, 1

    s_lshl_b32 s13, s12, 10
    s_add_u32 m0, s13, 147456
    s_add_u32 s12, s12, s18
    s_add_u32 s12, s12, 16
    s_sub_u32 s13, s12, 18
    s_cmp_ge_u32 s12, 18
    s_cselect_b32 s12, s13, s12
    s_mul_i32 s12, s12, 294912

    buffer_load_dwordx4 v5, s[44:47], s12 offen lds
    buffer_load_dwordx2 v[24:25], v3, s[60:63], 0 offen sc1
    s_mul_i32 s12, s3, 18
    s_lshl_b32 s13, s18, 2
    s_add_u32 s13, s13, s12
    s_sub_u32 s97, s13, 72
    s_cmp_ge_u32 s13, 72
    s_cselect_b32 s13, s97, s13
    s_mul_i32 s97, s13, 73728
    s_add_u32 s97, s97, s17

    s_lshl_b32 s96, s12, 10
    s_add_u32 s96, s96, 0
    s_add_u32 s98, s96, 18432
    s_add_u32 s12, s12, s30

    s_lshl_b32 s13, s18, 2
    s_add_u32 s13, s13, s12
    s_sub_u32 s20, s13, 72
    s_cmp_ge_u32 s13, 72
    s_cselect_b32 s13, s20, s13
    s_mul_i32 s20, s13, 73728
    s_add_u32 s20, s20, s17

    s_add_u32 s21, s17, 5308416
    s_lshl_b32 s12, s12, 10
    s_add_u32 m0, s12, 0
    s_nop 0
    buffer_load_dwordx4 v4, s[44:47], s20 offen lds
    s_add_u32 m0, m0, 1024
    s_add_u32 s20, s20, 73728
    buffer_load_dwordx4 v4, s[44:47], s20 offen lds
    s_add_u32 m0, m0, 1024
    s_add_u32 s20, s20, 73728
    s_cmp_eq_u32 s20, s21
    s_cselect_b32 s20, s17, s20
    s_cmp_eq_u32 m0, s98
    s_cselect_b32 m0, s96, m0
    s_cselect_b32 s20, s97, s20
    buffer_load_dwordx4 v4, s[44:47], s20 offen lds
    s_add_u32 m0, m0, 1024
    s_add_u32 s20, s20, 73728
    buffer_load_dwordx4 v4, s[44:47], s20 offen lds
    s_add_u32 m0, m0, 1024
    s_add_u32 s20, s20, 73728
    s_cmp_eq_u32 s20, s21
    s_cselect_b32 s20, s17, s20
    s_cmp_eq_u32 m0, s98
    s_cselect_b32 m0, s96, m0
    s_cselect_b32 s20, s97, s20
    buffer_load_dwordx4 v4, s[44:47], s20 offen lds
    s_add_u32 m0, m0, 1024
    s_add_u32 s20, s20, 73728
    buffer_load_dwordx4 v4, s[44:47], s20 offen lds
    s_add_u32 m0, m0, 1024
    s_add_u32 s20, s20, 73728
    s_cmp_eq_u32 s20, s21
    s_cselect_b32 s20, s17, s20
    s_cmp_eq_u32 m0, s98
    s_cselect_b32 m0, s96, m0
    s_cselect_b32 s20, s97, s20
    buffer_load_dwordx4 v4, s[44:47], s20 offen lds
    s_add_u32 m0, m0, 1024
    s_add_u32 s20, s20, 73728
    buffer_load_dwordx4 v4, s[44:47], s20 offen lds
    s_add_u32 m0, m0, 1024
    s_add_u32 s20, s20, 73728
    s_cmp_eq_u32 s20, s21
    s_cselect_b32 s20, s17, s20
    s_cmp_eq_u32 m0, s98
    s_cselect_b32 m0, s96, m0
    s_cselect_b32 s20, s97, s20
    buffer_load_dwordx4 v4, s[44:47], s20 offen lds
    s_add_u32 m0, m0, 1024
    s_add_u32 s20, s20, 73728
    buffer_load_dwordx4 v4, s[44:47], s20 offen lds
    s_add_u32 m0, m0, 1024
    s_add_u32 s20, s20, 73728
    s_cmp_eq_u32 s20, s21
    s_cselect_b32 s20, s17, s20
    s_cmp_eq_u32 m0, s98
    s_cselect_b32 m0, s96, m0
    s_cselect_b32 s20, s97, s20
    buffer_load_dwordx4 v4, s[44:47], s20 offen lds
    s_add_u32 m0, m0, 1024
    s_add_u32 s20, s20, 73728
    buffer_load_dwordx4 v4, s[44:47], s20 offen lds
    s_add_u32 m0, m0, 1024
    s_add_u32 s20, s20, 73728
    s_cmp_eq_u32 s20, s21
    s_cselect_b32 s20, s17, s20
    s_cmp_eq_u32 m0, s98
    s_cselect_b32 m0, s96, m0
    s_cselect_b32 s20, s97, s20
    buffer_load_dwordx4 v4, s[44:47], s20 offen lds
    s_add_u32 m0, m0, 1024
    s_add_u32 s20, s20, 73728
    buffer_load_dwordx4 v4, s[44:47], s20 offen lds
    s_add_u32 m0, m0, 1024
    s_add_u32 s20, s20, 73728
    s_cmp_eq_u32 s20, s21
    s_cselect_b32 s20, s17, s20
    s_cmp_eq_u32 m0, s98
    s_cselect_b32 m0, s96, m0
    s_cselect_b32 s20, s97, s20
    buffer_load_dwordx4 v4, s[44:47], s20 offen lds
    s_add_u32 m0, m0, 1024
    s_add_u32 s20, s20, 73728
    buffer_load_dwordx4 v4, s[44:47], s20 offen lds
    s_add_u32 m0, m0, 1024
    s_add_u32 s20, s20, 73728
    s_cmp_eq_u32 s20, s21
    s_cselect_b32 s20, s17, s20
    s_cmp_eq_u32 m0, s98
    s_cselect_b32 m0, s96, m0
    s_cselect_b32 s20, s97, s20
    buffer_load_dwordx4 v4, s[44:47], s20 offen lds
    s_add_u32 m0, m0, 1024
    s_add_u32 s20, s20, 73728
    buffer_load_dwordx4 v4, s[44:47], s20 offen lds
    s_waitcnt vmcnt(18)
    s_barrier
    ds_read_b64_tr_b16 a[192:193], v13 offset:0
    ds_read_b64_tr_b16 a[194:195], v13 offset:256
    ds_read_b64_tr_b16 a[196:197], v13 offset:1024
    ds_read_b64_tr_b16 a[198:199], v13 offset:1280
    v_cmp_ne_u32 vcc, 0, v25
    s_cbranch_vccnz non_3_ok
    s_mov_b32 s14, 0
non_3:
    s_sleep 1
    buffer_load_dwordx2 v[24:25], v3, s[60:63], 0 offen sc1
    s_add_u32 s14, s14, 1
    s_cmp_gt_u32 s14, 0x8000
    s_cbranch_scc1 non_3_ok
    s_waitcnt vmcnt(0)
    v_cmp_ne_u32 vcc, 0, v25
    s_cbranch_vccz non_3
non_3_ok:

    s_cmp_ge_u32 s5, 26
    s_cbranch_scc1 L_norp3
    s_cmp_lg_u32 s3, 0
    s_cbranch_scc1 L_norp3
    s_sub_u32 s12, s5, 18
    s_lshl_b32 s12, s12, 3
    s_lshl_b32 s13, s101, 7
    s_add_u32 s12, s12, s13
    s_add_u32 s12, s12, 2580480
    buffer_store_dwordx2 v[24:25], v19, s[52:55], s12 offen sc1
L_norp3:

    s_mul_i32 s12, s3, 18
    s_lshl_b32 s13, s18, 2
    s_add_u32 s13, s13, s12
    s_sub_u32 s97, s13, 72
    s_cmp_ge_u32 s13, 72
    s_cselect_b32 s13, s97, s13
    s_mul_i32 s97, s13, 73728
    s_add_u32 s97, s97, s25

    s_lshl_b32 s96, s12, 10
    s_add_u32 s96, s96, 73728
    s_add_u32 s98, s96, 18432
    s_add_u32 s12, s12, s30

    s_lshl_b32 s13, s18, 2
    s_add_u32 s13, s13, s12
    s_sub_u32 s20, s13, 72
    s_cmp_ge_u32 s13, 72
    s_cselect_b32 s13, s20, s13
    s_mul_i32 s20, s13, 73728
    s_add_u32 s20, s20, s25

    s_add_u32 s21, s25, 5308416
    s_lshl_b32 s12, s12, 10
    s_add_u32 m0, s12, 73728
    s_nop 0
    buffer_load_dwordx4 v4, s[44:47], s20 offen lds
    s_add_u32 m0, m0, 1024
    s_add_u32 s20, s20, 73728
    buffer_load_dwordx4 v4, s[44:47], s20 offen lds
    s_add_u32 m0, m0, 1024
    s_add_u32 s20, s20, 73728
    s_cmp_eq_u32 s20, s21
    s_cselect_b32 s20, s25, s20
    s_cmp_eq_u32 m0, s98
    s_cselect_b32 m0, s96, m0
    s_cselect_b32 s20, s97, s20
    buffer_load_dwordx4 v4, s[44:47], s20 offen lds
    s_add_u32 m0, m0, 1024
    s_add_u32 s20, s20, 73728
    buffer_load_dwordx4 v4, s[44:47], s20 offen lds
    s_add_u32 m0, m0, 1024
    s_add_u32 s20, s20, 73728
    s_cmp_eq_u32 s20, s21
    s_cselect_b32 s20, s25, s20
    s_cmp_eq_u32 m0, s98
    s_cselect_b32 m0, s96, m0
    s_cselect_b32 s20, s97, s20
    buffer_load_dwordx4 v4, s[44:47], s20 offen lds
    s_add_u32 m0, m0, 1024
    s_add_u32 s20, s20, 73728
    buffer_load_dwordx4 v4, s[44:47], s20 offen lds
    s_add_u32 m0, m0, 1024
    s_add_u32 s20, s20, 73728
    s_cmp_eq_u32 s20, s21
    s_cselect_b32 s20, s25, s20
    s_cmp_eq_u32 m0, s98
    s_cselect_b32 m0, s96, m0
    s_cselect_b32 s20, s97, s20
    buffer_load_dwordx4 v4, s[44:47], s20 offen lds
    s_add_u32 m0, m0, 1024
    s_add_u32 s20, s20, 73728
    buffer_load_dwordx4 v4, s[44:47], s20 offen lds
    s_add_u32 m0, m0, 1024
    s_add_u32 s20, s20, 73728
    s_cmp_eq_u32 s20, s21
    s_cselect_b32 s20, s25, s20
    s_cmp_eq_u32 m0, s98
    s_cselect_b32 m0, s96, m0
    s_cselect_b32 s20, s97, s20
    buffer_load_dwordx4 v4, s[44:47], s20 offen lds
    s_add_u32 m0, m0, 1024
    s_add_u32 s20, s20, 73728
    buffer_load_dwordx4 v4, s[44:47], s20 offen lds
    s_add_u32 m0, m0, 1024
    s_add_u32 s20, s20, 73728
    s_cmp_eq_u32 s20, s21
    s_cselect_b32 s20, s25, s20
    s_cmp_eq_u32 m0, s98
    s_cselect_b32 m0, s96, m0
    s_cselect_b32 s20, s97, s20
    buffer_load_dwordx4 v4, s[44:47], s20 offen lds
    s_add_u32 m0, m0, 1024
    s_add_u32 s20, s20, 73728
    buffer_load_dwordx4 v4, s[44:47], s20 offen lds
    s_add_u32 m0, m0, 1024
    s_add_u32 s20, s20, 73728
    s_cmp_eq_u32 s20, s21
    s_cselect_b32 s20, s25, s20
    s_cmp_eq_u32 m0, s98
    s_cselect_b32 m0, s96, m0
    s_cselect_b32 s20, s97, s20
    buffer_load_dwordx4 v4, s[44:47], s20 offen lds
    s_add_u32 m0, m0, 1024
    s_add_u32 s20, s20, 73728
    buffer_load_dwordx4 v4, s[44:47], s20 offen lds
    s_add_u32 m0, m0, 1024
    s_add_u32 s20, s20, 73728
    s_cmp_eq_u32 s20, s21
    s_cselect_b32 s20, s25, s20
    s_cmp_eq_u32 m0, s98
    s_cselect_b32 m0, s96, m0
    s_cselect_b32 s20, s97, s20
    buffer_load_dwordx4 v4, s[44:47], s20 offen lds
    s_add_u32 m0, m0, 1024
    s_add_u32 s20, s20, 73728
    buffer_load_dwordx4 v4, s[44:47], s20 offen lds
    s_add_u32 m0, m0, 1024
    s_add_u32 s20, s20, 73728
    s_cmp_eq_u32 s20, s21
    s_cselect_b32 s20, s25, s20
    s_cmp_eq_u32 m0, s98
    s_cselect_b32 m0, s96, m0
    s_cselect_b32 s20, s97, s20
    buffer_load_dwordx4 v4, s[44:47], s20 offen lds
    s_add_u32 m0, m0, 1024
    s_add_u32 s20, s20, 73728
    buffer_load_dwordx4 v4, s[44:47], s20 offen lds
    s_waitcnt lgkmcnt(0)
    s_barrier
    s_waitcnt vmcnt(0)
    s_barrier
    s_cmp_lt_u32 s5, 24
    s_cbranch_scc1 L_cstart2
    s_sub_u32 s14, s9, 6
    s_mul_i32 s12, s14, 73728
    s_lshl_b32 s13, s3, 5
    v_xor_b32 v14, s13, v6
    v_add_u32 v14, s12, v14
    v_add_u32 v252, 36864, v14
    v_mov_b32 v216, v18
    v_mov_b32 v217, v18
    v_mov_b32 v218, v18
    v_mov_b32 v219, v18

    ds_read_b64_tr_b16 v[112:113], v14 offset:0
    ds_read_b64_tr_b16 v[114:115], v14 offset:1024
    ds_read_b64_tr_b16 v[116:117], v14 offset:4096
    ds_read_b64_tr_b16 v[118:119], v14 offset:5120
    ds_read_b64_tr_b16 v[120:121], v14 offset:8192
    ds_read_b64_tr_b16 v[122:123], v14 offset:9216
    ds_read_b64_tr_b16 v[124:125], v14 offset:12288
    ds_read_b64_tr_b16 v[126:127], v14 offset:13312
    ds_read_b64_tr_b16 v[128:129], v14 offset:16384
    ds_read_b64_tr_b16 v[130:131], v14 offset:17408
    ds_read_b64_tr_b16 v[132:133], v14 offset:20480
    ds_read_b64_tr_b16 v[134:135], v14 offset:21504
    s_waitcnt lgkmcnt(10)
    v_mfma_f32_16x16x32_bf16 v[136:139], v[216:219], v[112:115], 0
    s_waitcnt lgkmcnt(4)
    ds_read_b64_tr_b16 v[104:105], v14 offset:24576
    ds_read_b64_tr_b16 v[106:107], v14 offset:25600
    v_mfma_f32_16x16x32_bf16 v[136:139], v[216:219], v[116:119], v[136:139]
    ds_read_b64_tr_b16 v[108:109], v14 offset:28672
    ds_read_b64_tr_b16 v[110:111], v14 offset:29696
    v_mfma_f32_16x16x32_bf16 v[136:139], v[216:219], v[120:123], v[136:139]
    ds_read_b64_tr_b16 v[112:113], v14 offset:32768
    ds_read_b64_tr_b16 v[114:115], v14 offset:33792
    v_mfma_f32_16x16x32_bf16 v[136:139], v[216:219], v[124:127], v[136:139]
    s_waitcnt lgkmcnt(4)
    ds_read_b64_tr_b16 v[116:117], v252 offset:0
    ds_read_b64_tr_b16 v[118:119], v252 offset:1024
    v_mfma_f32_16x16x32_bf16 v[136:139], v[216:219], v[128:131], v[136:139]
    ds_read_b64_tr_b16 v[120:121], v252 offset:4096
    ds_read_b64_tr_b16 v[122:123], v252 offset:5120
    v_mfma_f32_16x16x32_bf16 v[136:139], v[216:219], v[132:135], v[136:139]
    ds_read_b64_tr_b16 v[124:125], v252 offset:8192
    ds_read_b64_tr_b16 v[126:127], v252 offset:9216
    v_mfma_f32_16x16x32_bf16 v[136:139], v[216:219], v[104:107], v[136:139]
    s_waitcnt lgkmcnt(4)
    ds_read_b64_tr_b16 v[128:129], v252 offset:12288
    ds_read_b64_tr_b16 v[130:131], v252 offset:13312
    v_mfma_f32_16x16x32_bf16 v[136:139], v[216:219], v[108:111], v[136:139]
    ds_read_b64_tr_b16 v[132:133], v252 offset:16384
    ds_read_b64_tr_b16 v[134:135], v252 offset:17408
    v_mfma_f32_16x16x32_bf16 v[136:139], v[216:219], v[112:115], v[136:139]
    ds_read_b64_tr_b16 v[104:105], v252 offset:20480
    ds_read_b64_tr_b16 v[106:107], v252 offset:21504
    v_mfma_f32_16x16x32_bf16 v[136:139], v[216:219], v[116:119], v[136:139]
    s_waitcnt lgkmcnt(4)
    ds_read_b64_tr_b16 v[108:109], v252 offset:24576
    ds_read_b64_tr_b16 v[110:111], v252 offset:25600
    v_mfma_f32_16x16x32_bf16 v[136:139], v[216:219], v[120:123], v[136:139]
    ds_read_b64_tr_b16 v[112:113], v252 offset:28672
    ds_read_b64_tr_b16 v[114:115], v252 offset:29696
    v_mfma_f32_16x16x32_bf16 v[136:139], v[216:219], v[124:127], v[136:139]
    ds_read_b64_tr_b16 v[116:117], v252 offset:32768
    ds_read_b64_tr_b16 v[118:119], v252 offset:33792
    v_mfma_f32_16x16x32_bf16 v[136:139], v[216:219], v[128:131], v[136:139]
    s_waitcnt lgkmcnt(4)
    v_mfma_f32_16x16x32_bf16 v[136:139], v[216:219], v[132:135], v[136:139]
    v_mfma_f32_16x16x32_bf16 v[136:139], v[216:219], v[104:107], v[136:139]
    v_mfma_f32_16x16x32_bf16 v[136:139], v[216:219], v[108:111], v[136:139]
    s_waitcnt lgkmcnt(0)
    v_mfma_f32_16x16x32_bf16 v[136:139], v[216:219], v[112:115], v[136:139]
    v_mfma_f32_16x16x32_bf16 v[136:139], v[216:219], v[116:119], v[136:139]
    s_lshl_b32 s14, s14, 2
    s_add_u32 s14, s14, s3
    s_lshl_b32 s12, s16, 10
    s_add_u32 s12, s12, 2490368
    s_lshl_b32 s13, s14, 7
    s_add_u32 s13, s13, s12
    v_lshlrev_b32 v29, 3, v0
    v_cmp_gt_u32 vcc, 16, v0
    v_mov_b32 v30, 0x7ff00000
    s_nop 1
    v_cndmask_b32 v29, v30, v29, vcc
    v_and_b32 v137, 0xffff0000, v136
    v_sub_f32 v136, v136, v137
    v_and_b32 v138, 0xffff0000, v136
    v_sub_f32 v136, v136, v138
    v_cvt_pk_bf16_f32 v138, v137, v138
    v_cvt_pk_bf16_f32 v139, v136, 0
    buffer_store_dwordx2 v[138:139], v29, s[52:55], s13 offen sc1
    s_lshl_b32 s13, s16, 6
    s_lshl_b32 s14, s14, 3
    s_add_u32 s13, s13, s14
    s_add_u32 s13, s13, 2572288
    s_waitcnt vmcnt(0)
    buffer_store_dwordx2 v[24:25], v19, s[52:55], s13 offen sc1
L_cstart2:

    s_lshl_b32 s12, s9, 2
    s_add_u32 s12, s12, s3
    s_lshl_b32 s12, s12, 8
    s_add_u32 s12, s12, 2564096
    v_lshlrev_b32 v22, 3, v0
    v_min_u32 v22, 248, v22
    v_add_u32 v22, s12, v22
    s_mul_i32 s30, s16, 18432
    s_add_u32 s30, s30, 31457280

    buffer_load_dwordx2 v[20:21], v22, s[52:55], 0 offen offset:0 sc1
    s_mul_i32 s27, s19, 18432
    s_add_u32 s27, s27, 1179648
    s_lshl_b32 s26, s18, 10
    s_add_u32 s26, s26, s27
    s_add_u32 s31, s27, 18432

    v_add_u32 v14, 0, v6
    v_add_u32 v252, 73728, v6
    v_add_u32 v15, 0, v7
    v_add_u32 v253, 73728, v7
    v_add_u32 v16, 0, v8
    v_add_u32 v254, 73728, v8
    v_add_u32 v17, 0, v9
    v_add_u32 v255, 73728, v9
    s_waitcnt vmcnt(0)
    v_cmp_ne_u64 vcc, v[20:21], v[24:25]
    s_and_b32 s12, vcc_lo, 0x3ffff
    s_cbranch_scc0 poll_4_ok
    s_mov_b32 s14, 0
poll_4:
    s_sleep 12
    buffer_load_dwordx2 v[20:21], v22, s[52:55], 0 offen offset:0 sc1
    s_add_u32 s14, s14, 1
    s_cmp_gt_u32 s14, 0x8000
    s_cbranch_scc1 poll_4_ok
    s_waitcnt vmcnt(0)
    v_cmp_ne_u64 vcc, v[20:21], v[24:25]
    s_and_b32 s12, vcc_lo, 0x3ffff
    s_cbranch_scc1 poll_4
poll_4_ok:

    buffer_load_dwordx4 a[0:3], v10, s[52:55], s26 offen sc1
    buffer_load_dwordx4 a[72:75], v11, s[52:55], s26 offen sc1
    s_add_u32 s26, s26, 1024
    s_cmp_eq_u32 s26, s31
    s_cselect_b32 s26, s27, s26
    buffer_load_dwordx4 a[4:7], v10, s[52:55], s26 offen sc1
    buffer_load_dwordx4 a[76:79], v11, s[52:55], s26 offen sc1
    s_add_u32 s26, s26, 1024
    s_cmp_eq_u32 s26, s31
    s_cselect_b32 s26, s27, s26
    buffer_load_dwordx4 a[8:11], v10, s[52:55], s26 offen sc1
    buffer_load_dwordx4 a[80:83], v11, s[52:55], s26 offen sc1
    s_add_u32 s26, s26, 1024
    s_cmp_eq_u32 s26, s31
    s_cselect_b32 s26, s27, s26
    buffer_load_dwordx4 a[12:15], v10, s[52:55], s26 offen sc1
    buffer_load_dwordx4 a[84:87], v11, s[52:55], s26 offen sc1
    s_add_u32 s26, s26, 1024
    s_cmp_eq_u32 s26, s31
    s_cselect_b32 s26, s27, s26
    buffer_load_dwordx4 a[16:19], v10, s[52:55], s26 offen sc1
    buffer_load_dwordx4 a[88:91], v11, s[52:55], s26 offen sc1
    s_add_u32 s26, s26, 1024
    s_cmp_eq_u32 s26, s31
    s_cselect_b32 s26, s27, s26
    ds_read_b64_tr_b16 v[120:121], v14 offset:0
    ds_read_b64_tr_b16 v[122:123], v14 offset:1024
    ds_read_b64_tr_b16 v[124:125], v15 offset:0
    ds_read_b64_tr_b16 v[126:127], v15 offset:1024
    ds_read_b64_tr_b16 v[128:129], v16 offset:0
    ds_read_b64_tr_b16 v[130:131], v16 offset:1024
    ds_read_b64_tr_b16 v[132:133], v17 offset:0
    ds_read_b64_tr_b16 v[134:135], v17 offset:1024
    ds_read_b64_tr_b16 v[104:105], v252 offset:0
    ds_read_b64_tr_b16 v[106:107], v252 offset:1024
    s_waitcnt lgkmcnt(8)
    s_waitcnt vmcnt(8)
    v_mfma_f32_16x16x32_bf16 v[136:139], v[120:123], a[0:3], 0
    ds_read_b64_tr_b16 v[108:109], v253 offset:0
    buffer_load_dwordx4 a[20:23], v10, s[52:55], s26 offen sc1
    buffer_load_dwordx4 a[92:95], v11, s[52:55], s26 offen sc1
    s_add_u32 s26, s26, 1024
    s_cmp_eq_u32 s26, s31
    s_cselect_b32 s26, s27, s26
    v_mfma_f32_16x16x32_bf16 v[140:143], v[120:123], a[72:75], 0
    s_waitcnt lgkmcnt(5)
    ds_read_b64_tr_b16 v[110:111], v253 offset:1024
    v_mfma_f32_16x16x32_bf16 v[144:147], v[124:127], a[0:3], 0
    ds_read_b64_tr_b16 v[112:113], v14 offset:4096
    v_mfma_f32_16x16x32_bf16 v[148:151], v[124:127], a[72:75], 0
    ds_read_b64_tr_b16 v[114:115], v14 offset:5120
    v_mfma_f32_16x16x32_bf16 v[152:155], v[128:131], a[0:3], 0
    ds_read_b64_tr_b16 v[116:117], v15 offset:4096
    v_mfma_f32_16x16x32_bf16 v[156:159], v[128:131], a[72:75], 0
    s_waitcnt lgkmcnt(5)
    ds_read_b64_tr_b16 v[118:119], v15 offset:5120
    v_mfma_f32_16x16x32_bf16 v[160:163], v[132:135], a[0:3], 0
    ds_read_b64_tr_b16 v[120:121], v16 offset:4096
    v_mfma_f32_16x16x32_bf16 v[164:167], v[132:135], a[72:75], 0
    ds_read_b64_tr_b16 v[122:123], v16 offset:5120
    v_mfma_f32_16x16x32_bf16 v[168:171], v[104:107], a[0:3], 0
    ds_read_b64_tr_b16 v[124:125], v17 offset:4096
    v_mfma_f32_16x16x32_bf16 v[172:175], v[104:107], a[72:75], 0
    s_waitcnt lgkmcnt(5)
    ds_read_b64_tr_b16 v[126:127], v17 offset:5120
    v_mfma_f32_16x16x32_bf16 v[176:179], v[108:111], a[0:3], 0
    ds_read_b64_tr_b16 v[128:129], v252 offset:4096
    buffer_load_dwordx4 a[24:27], v10, s[52:55], s26 offen sc1
    buffer_load_dwordx4 a[96:99], v11, s[52:55], s26 offen sc1
    s_add_u32 s26, s26, 1024
    s_cmp_eq_u32 s26, s31
    s_cselect_b32 s26, s27, s26
    v_mfma_f32_16x16x32_bf16 v[180:183], v[108:111], a[72:75], 0
    s_waitcnt vmcnt(10)
    ds_read_b64_tr_b16 v[130:131], v252 offset:5120
    v_mfma_f32_16x16x32_bf16 v[136:139], v[112:115], a[4:7], v[136:139]
    ds_read_b64_tr_b16 v[132:133], v253 offset:4096
    v_mfma_f32_16x16x32_bf16 v[140:143], v[112:115], a[76:79], v[140:143]
    s_waitcnt lgkmcnt(5)
    ds_read_b64_tr_b16 v[134:135], v253 offset:5120
    v_mfma_f32_16x16x32_bf16 v[144:147], v[116:119], a[4:7], v[144:147]
    ds_read_b64_tr_b16 v[104:105], v14 offset:8192
    v_mfma_f32_16x16x32_bf16 v[148:151], v[116:119], a[76:79], v[148:151]
    ds_read_b64_tr_b16 v[106:107], v14 offset:9216
    v_mfma_f32_16x16x32_bf16 v[152:155], v[120:123], a[4:7], v[152:155]
    ds_read_b64_tr_b16 v[108:109], v15 offset:8192
    v_mfma_f32_16x16x32_bf16 v[156:159], v[120:123], a[76:79], v[156:159]
    s_waitcnt lgkmcnt(5)
    ds_read_b64_tr_b16 v[110:111], v15 offset:9216
    v_mfma_f32_16x16x32_bf16 v[160:163], v[124:127], a[4:7], v[160:163]
    ds_read_b64_tr_b16 v[112:113], v16 offset:8192
    v_mfma_f32_16x16x32_bf16 v[164:167], v[124:127], a[76:79], v[164:167]
    ds_read_b64_tr_b16 v[114:115], v16 offset:9216
    v_mfma_f32_16x16x32_bf16 v[168:171], v[128:131], a[4:7], v[168:171]
    ds_read_b64_tr_b16 v[116:117], v17 offset:8192
    buffer_load_dwordx4 a[28:31], v10, s[52:55], s26 offen sc1
    buffer_load_dwordx4 a[100:103], v11, s[52:55], s26 offen sc1
    s_add_u32 s26, s26, 1024
    s_cmp_eq_u32 s26, s31
    s_cselect_b32 s26, s27, s26
    v_mfma_f32_16x16x32_bf16 v[172:175], v[128:131], a[76:79], v[172:175]
    s_waitcnt lgkmcnt(5)
    ds_read_b64_tr_b16 v[118:119], v17 offset:9216
    v_mfma_f32_16x16x32_bf16 v[176:179], v[132:135], a[4:7], v[176:179]
    ds_read_b64_tr_b16 v[120:121], v252 offset:8192
    v_mfma_f32_16x16x32_bf16 v[180:183], v[132:135], a[76:79], v[180:183]
    s_waitcnt vmcnt(10)
    ds_read_b64_tr_b16 v[122:123], v252 offset:9216
    v_mfma_f32_16x16x32_bf16 v[136:139], v[104:107], a[8:11], v[136:139]
    ds_read_b64_tr_b16 v[124:125], v253 offset:8192
    v_mfma_f32_16x16x32_bf16 v[140:143], v[104:107], a[80:83], v[140:143]
    s_waitcnt lgkmcnt(5)
    ds_read_b64_tr_b16 v[126:127], v253 offset:9216
    v_mfma_f32_16x16x32_bf16 v[144:147], v[108:111], a[8:11], v[144:147]
    ds_read_b64_tr_b16 v[128:129], v14 offset:12288
    v_mfma_f32_16x16x32_bf16 v[148:151], v[108:111], a[80:83], v[148:151]
    ds_read_b64_tr_b16 v[130:131], v14 offset:13312
    v_mfma_f32_16x16x32_bf16 v[152:155], v[112:115], a[8:11], v[152:155]
    ds_read_b64_tr_b16 v[132:133], v15 offset:12288
    v_mfma_f32_16x16x32_bf16 v[156:159], v[112:115], a[80:83], v[156:159]
    s_waitcnt lgkmcnt(5)
    ds_read_b64_tr_b16 v[134:135], v15 offset:13312
    v_mfma_f32_16x16x32_bf16 v[160:163], v[116:119], a[8:11], v[160:163]
    ds_read_b64_tr_b16 v[104:105], v16 offset:12288
    buffer_load_dwordx4 a[32:35], v10, s[52:55], s26 offen sc1
    buffer_load_dwordx4 a[104:107], v11, s[52:55], s26 offen sc1
    s_add_u32 s26, s26, 1024
    s_cmp_eq_u32 s26, s31
    s_cselect_b32 s26, s27, s26
    v_mfma_f32_16x16x32_bf16 v[164:167], v[116:119], a[80:83], v[164:167]
    ds_read_b64_tr_b16 v[106:107], v16 offset:13312
    v_mfma_f32_16x16x32_bf16 v[168:171], v[120:123], a[8:11], v[168:171]
    ds_read_b64_tr_b16 v[108:109], v17 offset:12288
    v_mfma_f32_16x16x32_bf16 v[172:175], v[120:123], a[80:83], v[172:175]
    s_waitcnt lgkmcnt(5)
    ds_read_b64_tr_b16 v[110:111], v17 offset:13312
    v_mfma_f32_16x16x32_bf16 v[176:179], v[124:127], a[8:11], v[176:179]
    ds_read_b64_tr_b16 v[112:113], v252 offset:12288
    v_mfma_f32_16x16x32_bf16 v[180:183], v[124:127], a[80:83], v[180:183]
    s_waitcnt vmcnt(10)
    ds_read_b64_tr_b16 v[114:115], v252 offset:13312
    v_mfma_f32_16x16x32_bf16 v[136:139], v[128:131], a[12:15], v[136:139]
    ds_read_b64_tr_b16 v[116:117], v253 offset:12288
    v_mfma_f32_16x16x32_bf16 v[140:143], v[128:131], a[84:87], v[140:143]
    s_waitcnt lgkmcnt(5)
    ds_read_b64_tr_b16 v[118:119], v253 offset:13312
    v_mfma_f32_16x16x32_bf16 v[144:147], v[132:135], a[12:15], v[144:147]
    ds_read_b64_tr_b16 v[120:121], v14 offset:16384
    v_mfma_f32_16x16x32_bf16 v[148:151], v[132:135], a[84:87], v[148:151]
    ds_read_b64_tr_b16 v[122:123], v14 offset:17408
    v_mfma_f32_16x16x32_bf16 v[152:155], v[104:107], a[12:15], v[152:155]
    ds_read_b64_tr_b16 v[124:125], v15 offset:16384
    buffer_load_dwordx4 a[36:39], v10, s[52:55], s26 offen sc1
    buffer_load_dwordx4 a[108:111], v11, s[52:55], s26 offen sc1
    s_add_u32 s26, s26, 1024
    s_cmp_eq_u32 s26, s31
    s_cselect_b32 s26, s27, s26
    v_mfma_f32_16x16x32_bf16 v[156:159], v[104:107], a[84:87], v[156:159]
    s_waitcnt lgkmcnt(5)
    ds_read_b64_tr_b16 v[126:127], v15 offset:17408
    v_mfma_f32_16x16x32_bf16 v[160:163], v[108:111], a[12:15], v[160:163]
    ds_read_b64_tr_b16 v[128:129], v16 offset:16384
    v_mfma_f32_16x16x32_bf16 v[164:167], v[108:111], a[84:87], v[164:167]
    ds_read_b64_tr_b16 v[130:131], v16 offset:17408
    v_mfma_f32_16x16x32_bf16 v[168:171], v[112:115], a[12:15], v[168:171]
    ds_read_b64_tr_b16 v[132:133], v17 offset:16384
    v_mfma_f32_16x16x32_bf16 v[172:175], v[112:115], a[84:87], v[172:175]
    s_waitcnt lgkmcnt(5)
    ds_read_b64_tr_b16 v[134:135], v17 offset:17408
    v_mfma_f32_16x16x32_bf16 v[176:179], v[116:119], a[12:15], v[176:179]
    ds_read_b64_tr_b16 v[104:105], v252 offset:16384
    v_mfma_f32_16x16x32_bf16 v[180:183], v[116:119], a[84:87], v[180:183]
    s_waitcnt vmcnt(10)
    ds_read_b64_tr_b16 v[106:107], v252 offset:17408
    v_mfma_f32_16x16x32_bf16 v[136:139], v[120:123], a[16:19], v[136:139]
    ds_read_b64_tr_b16 v[108:109], v253 offset:16384
    v_mfma_f32_16x16x32_bf16 v[140:143], v[120:123], a[88:91], v[140:143]
    s_waitcnt lgkmcnt(5)
    ds_read_b64_tr_b16 v[110:111], v253 offset:17408
    v_mfma_f32_16x16x32_bf16 v[144:147], v[124:127], a[16:19], v[144:147]
    ds_read_b64_tr_b16 v[112:113], v14 offset:20480
    buffer_load_dwordx4 a[40:43], v10, s[52:55], s26 offen sc1
    buffer_load_dwordx4 a[112:115], v11, s[52:55], s26 offen sc1
    s_add_u32 s26, s26, 1024
    s_cmp_eq_u32 s26, s31
    s_cselect_b32 s26, s27, s26
    v_mfma_f32_16x16x32_bf16 v[148:151], v[124:127], a[88:91], v[148:151]
    ds_read_b64_tr_b16 v[114:115], v14 offset:21504
    v_mfma_f32_16x16x32_bf16 v[152:155], v[128:131], a[16:19], v[152:155]
    ds_read_b64_tr_b16 v[116:117], v15 offset:20480
    v_mfma_f32_16x16x32_bf16 v[156:159], v[128:131], a[88:91], v[156:159]
    s_waitcnt lgkmcnt(5)
    ds_read_b64_tr_b16 v[118:119], v15 offset:21504
    v_mfma_f32_16x16x32_bf16 v[160:163], v[132:135], a[16:19], v[160:163]
    ds_read_b64_tr_b16 v[120:121], v16 offset:20480
    buffer_load_dwordx2 v[88:89], v80, s[52:55], 0 offen offset:0 sc1
    buffer_load_dwordx2 v[90:91], v80, s[52:55], 0 offen offset:128 sc1
    buffer_load_dwordx2 v[92:93], v80, s[52:55], 0 offen offset:256 sc1
    buffer_load_dwordx2 v[96:97], v80, s[52:55], 0 offen offset:2048 sc1
    buffer_load_dwordx2 v[98:99], v80, s[52:55], 0 offen offset:2176 sc1
    buffer_load_dwordx2 v[100:101], v80, s[52:55], 0 offen offset:2304 sc1
    v_mfma_f32_16x16x32_bf16 v[164:167], v[132:135], a[88:91], v[164:167]
    ds_read_b64_tr_b16 v[122:123], v16 offset:21504
    v_mfma_f32_16x16x32_bf16 v[168:171], v[104:107], a[16:19], v[168:171]
    ds_read_b64_tr_b16 v[124:125], v17 offset:20480
    v_mfma_f32_16x16x32_bf16 v[172:175], v[104:107], a[88:91], v[172:175]
    s_waitcnt lgkmcnt(5)
    ds_read_b64_tr_b16 v[126:127], v17 offset:21504
    v_mfma_f32_16x16x32_bf16 v[176:179], v[108:111], a[16:19], v[176:179]
    ds_read_b64_tr_b16 v[128:129], v252 offset:20480
    v_mfma_f32_16x16x32_bf16 v[180:183], v[108:111], a[88:91], v[180:183]
    s_waitcnt vmcnt(16)
    ds_read_b64_tr_b16 v[130:131], v252 offset:21504
    v_mfma_f32_16x16x32_bf16 v[136:139], v[112:115], a[20:23], v[136:139]
    ds_read_b64_tr_b16 v[132:133], v253 offset:20480
    buffer_load_dwordx4 a[44:47], v10, s[52:55], s26 offen sc1
    buffer_load_dwordx4 a[116:119], v11, s[52:55], s26 offen sc1
    s_add_u32 s26, s26, 1024
    s_cmp_eq_u32 s26, s31
    s_cselect_b32 s26, s27, s26
    v_mfma_f32_16x16x32_bf16 v[140:143], v[112:115], a[92:95], v[140:143]
    s_waitcnt lgkmcnt(5)
    ds_read_b64_tr_b16 v[134:135], v253 offset:21504
    v_mfma_f32_16x16x32_bf16 v[144:147], v[116:119], a[20:23], v[144:147]
    ds_read_b64_tr_b16 v[104:105], v14 offset:24576
    v_mfma_f32_16x16x32_bf16 v[148:151], v[116:119], a[92:95], v[148:151]
    ds_read_b64_tr_b16 v[106:107], v14 offset:25600
    v_mfma_f32_16x16x32_bf16 v[152:155], v[120:123], a[20:23], v[152:155]
    ds_read_b64_tr_b16 v[108:109], v15 offset:24576
    v_mfma_f32_16x16x32_bf16 v[156:159], v[120:123], a[92:95], v[156:159]
    s_waitcnt lgkmcnt(5)
    ds_read_b64_tr_b16 v[110:111], v15 offset:25600
    v_mfma_f32_16x16x32_bf16 v[160:163], v[124:127], a[20:23], v[160:163]
    ds_read_b64_tr_b16 v[112:113], v16 offset:24576
    v_mfma_f32_16x16x32_bf16 v[164:167], v[124:127], a[92:95], v[164:167]
    ds_read_b64_tr_b16 v[114:115], v16 offset:25600
    v_mfma_f32_16x16x32_bf16 v[168:171], v[128:131], a[20:23], v[168:171]
    ds_read_b64_tr_b16 v[116:117], v17 offset:24576
    v_mfma_f32_16x16x32_bf16 v[172:175], v[128:131], a[92:95], v[172:175]
    s_waitcnt lgkmcnt(5)
    ds_read_b64_tr_b16 v[118:119], v17 offset:25600
    v_mfma_f32_16x16x32_bf16 v[176:179], v[132:135], a[20:23], v[176:179]
    ds_read_b64_tr_b16 v[120:121], v252 offset:24576
    buffer_load_dwordx4 a[48:51], v10, s[52:55], s26 offen sc1
    buffer_load_dwordx4 a[120:123], v11, s[52:55], s26 offen sc1
    s_add_u32 s26, s26, 1024
    s_cmp_eq_u32 s26, s31
    s_cselect_b32 s26, s27, s26
    v_mfma_f32_16x16x32_bf16 v[180:183], v[132:135], a[92:95], v[180:183]
    s_waitcnt vmcnt(18)
    ds_read_b64_tr_b16 v[122:123], v252 offset:25600
    v_mfma_f32_16x16x32_bf16 v[136:139], v[104:107], a[24:27], v[136:139]
    ds_read_b64_tr_b16 v[124:125], v253 offset:24576
    v_mfma_f32_16x16x32_bf16 v[140:143], v[104:107], a[96:99], v[140:143]
    s_waitcnt lgkmcnt(5)
    ds_read_b64_tr_b16 v[126:127], v253 offset:25600
    v_mfma_f32_16x16x32_bf16 v[144:147], v[108:111], a[24:27], v[144:147]
    ds_read_b64_tr_b16 v[128:129], v14 offset:28672
    v_mfma_f32_16x16x32_bf16 v[148:151], v[108:111], a[96:99], v[148:151]
    ds_read_b64_tr_b16 v[130:131], v14 offset:29696
    v_mfma_f32_16x16x32_bf16 v[152:155], v[112:115], a[24:27], v[152:155]
    ds_read_b64_tr_b16 v[132:133], v15 offset:28672
    v_mfma_f32_16x16x32_bf16 v[156:159], v[112:115], a[96:99], v[156:159]
    s_waitcnt lgkmcnt(5)
    ds_read_b64_tr_b16 v[134:135], v15 offset:29696
    v_mfma_f32_16x16x32_bf16 v[160:163], v[116:119], a[24:27], v[160:163]
    ds_read_b64_tr_b16 v[104:105], v16 offset:28672
    v_mfma_f32_16x16x32_bf16 v[164:167], v[116:119], a[96:99], v[164:167]
    ds_read_b64_tr_b16 v[106:107], v16 offset:29696
    v_mfma_f32_16x16x32_bf16 v[168:171], v[120:123], a[24:27], v[168:171]
    ds_read_b64_tr_b16 v[108:109], v17 offset:28672
    buffer_load_dwordx4 a[52:55], v10, s[52:55], s26 offen sc1
    buffer_load_dwordx4 a[124:127], v11, s[52:55], s26 offen sc1
    s_add_u32 s26, s26, 1024
    s_cmp_eq_u32 s26, s31
    s_cselect_b32 s26, s27, s26
    v_mfma_f32_16x16x32_bf16 v[172:175], v[120:123], a[96:99], v[172:175]
    s_waitcnt lgkmcnt(5)
    ds_read_b64_tr_b16 v[110:111], v17 offset:29696
    v_mfma_f32_16x16x32_bf16 v[176:179], v[124:127], a[24:27], v[176:179]
    ds_read_b64_tr_b16 v[112:113], v252 offset:28672
    v_mfma_f32_16x16x32_bf16 v[180:183], v[124:127], a[96:99], v[180:183]
    s_waitcnt vmcnt(18)
    ds_read_b64_tr_b16 v[114:115], v252 offset:29696
    v_mfma_f32_16x16x32_bf16 v[136:139], v[128:131], a[28:31], v[136:139]
    ds_read_b64_tr_b16 v[116:117], v253 offset:28672
    v_mfma_f32_16x16x32_bf16 v[140:143], v[128:131], a[100:103], v[140:143]
    s_waitcnt lgkmcnt(5)
    ds_read_b64_tr_b16 v[118:119], v253 offset:29696
    v_mfma_f32_16x16x32_bf16 v[144:147], v[132:135], a[28:31], v[144:147]
    ds_read_b64_tr_b16 v[120:121], v14 offset:32768
    v_mfma_f32_16x16x32_bf16 v[148:151], v[132:135], a[100:103], v[148:151]
    ds_read_b64_tr_b16 v[122:123], v14 offset:33792
    v_mfma_f32_16x16x32_bf16 v[152:155], v[104:107], a[28:31], v[152:155]
    ds_read_b64_tr_b16 v[124:125], v15 offset:32768
    s_lshl_b32 s13, s16, 6
    s_add_u32 s13, s13, 2572288
    s_lshl_b32 s12, s4, 7
    s_add_u32 s12, s12, 2580416
    v_lshlrev_b32 v29, 3, v2
    v_cmp_gt_u32 vcc, 8, v2
    v_add_u32 v22, s13, v29
    v_add_u32 v29, s12, v29
    v_cndmask_b32 v22, v29, v22, vcc

    buffer_load_dwordx2 v[20:21], v22, s[52:55], 0 offen offset:0 sc1
    v_mfma_f32_16x16x32_bf16 v[156:159], v[104:107], a[100:103], v[156:159]
    s_waitcnt lgkmcnt(5)
    ds_read_b64_tr_b16 v[126:127], v15 offset:33792
    v_mfma_f32_16x16x32_bf16 v[160:163], v[108:111], a[28:31], v[160:163]
    ds_read_b64_tr_b16 v[128:129], v16 offset:32768
    buffer_load_dwordx4 a[56:59], v10, s[52:55], s26 offen sc1
    buffer_load_dwordx4 a[128:131], v11, s[52:55], s26 offen sc1
    s_add_u32 s26, s26, 1024
    s_cmp_eq_u32 s26, s31
    s_cselect_b32 s26, s27, s26
    v_mfma_f32_16x16x32_bf16 v[164:167], v[108:111], a[100:103], v[164:167]
    ds_read_b64_tr_b16 v[130:131], v16 offset:33792
    v_mfma_f32_16x16x32_bf16 v[168:171], v[112:115], a[28:31], v[168:171]
    ds_read_b64_tr_b16 v[132:133], v17 offset:32768
    v_mfma_f32_16x16x32_bf16 v[172:175], v[112:115], a[100:103], v[172:175]
    s_waitcnt lgkmcnt(5)
    ds_read_b64_tr_b16 v[134:135], v17 offset:33792
    v_mfma_f32_16x16x32_bf16 v[176:179], v[116:119], a[28:31], v[176:179]
    ds_read_b64_tr_b16 v[104:105], v252 offset:32768
    v_mfma_f32_16x16x32_bf16 v[180:183], v[116:119], a[100:103], v[180:183]
    s_waitcnt vmcnt(19)
    ds_read_b64_tr_b16 v[106:107], v252 offset:33792
    v_mfma_f32_16x16x32_bf16 v[136:139], v[120:123], a[32:35], v[136:139]
    ds_read_b64_tr_b16 v[108:109], v253 offset:32768
    v_mfma_f32_16x16x32_bf16 v[140:143], v[120:123], a[104:107], v[140:143]
    s_waitcnt lgkmcnt(5)
    ds_read_b64_tr_b16 v[110:111], v253 offset:33792
    v_mfma_f32_16x16x32_bf16 v[144:147], v[124:127], a[32:35], v[144:147]
    v_mfma_f32_16x16x32_bf16 v[148:151], v[124:127], a[104:107], v[148:151]
    v_mfma_f32_16x16x32_bf16 v[152:155], v[128:131], a[32:35], v[152:155]
    buffer_load_dwordx4 a[60:63], v10, s[52:55], s26 offen sc1
    buffer_load_dwordx4 a[132:135], v11, s[52:55], s26 offen sc1
    s_add_u32 s26, s26, 1024
    s_cmp_eq_u32 s26, s31
    s_cselect_b32 s26, s27, s26
    v_mfma_f32_16x16x32_bf16 v[156:159], v[128:131], a[104:107], v[156:159]
    s_waitcnt lgkmcnt(2)
    v_mfma_f32_16x16x32_bf16 v[160:163], v[132:135], a[32:35], v[160:163]
    v_mfma_f32_16x16x32_bf16 v[164:167], v[132:135], a[104:107], v[164:167]
    v_mfma_f32_16x16x32_bf16 v[168:171], v[104:107], a[32:35], v[168:171]
    v_mfma_f32_16x16x32_bf16 v[172:175], v[104:107], a[104:107], v[172:175]
    s_waitcnt lgkmcnt(0)
    v_mfma_f32_16x16x32_bf16 v[176:179], v[108:111], a[32:35], v[176:179]
    v_mfma_f32_16x16x32_bf16 v[180:183], v[108:111], a[104:107], v[180:183]
    v_add_u32 v14, 36864, v14
    v_add_u32 v15, 36864, v15
    v_add_u32 v16, 36864, v16
    v_add_u32 v17, 36864, v17
    v_add_u32 v252, 36864, v252
    v_add_u32 v253, 36864, v253
    s_barrier
    ds_read_b64_tr_b16 v[112:113], v14 offset:0
    ds_read_b64_tr_b16 v[114:115], v14 offset:1024
    ds_read_b64_tr_b16 v[116:117], v15 offset:0
    ds_read_b64_tr_b16 v[118:119], v15 offset:1024
    ds_read_b64_tr_b16 v[120:121], v16 offset:0
    ds_read_b64_tr_b16 v[122:123], v16 offset:1024
    ds_read_b64_tr_b16 v[124:125], v17 offset:0
    ds_read_b64_tr_b16 v[126:127], v17 offset:1024
    ds_read_b64_tr_b16 v[128:129], v252 offset:0
    ds_read_b64_tr_b16 v[130:131], v252 offset:1024
    s_waitcnt lgkmcnt(8)
    s_waitcnt vmcnt(19)
    v_mfma_f32_16x16x32_bf16 v[136:139], v[112:115], a[36:39], v[136:139]
    ds_read_b64_tr_b16 v[132:133], v253 offset:0
    v_mfma_f32_16x16x32_bf16 v[140:143], v[112:115], a[108:111], v[140:143]
    s_waitcnt lgkmcnt(5)
    ds_read_b64_tr_b16 v[134:135], v253 offset:1024
    v_mfma_f32_16x16x32_bf16 v[144:147], v[116:119], a[36:39], v[144:147]
    ds_read_b64_tr_b16 v[104:105], v14 offset:4096
    buffer_load_dwordx4 a[64:67], v10, s[52:55], s26 offen sc1
    buffer_load_dwordx4 a[136:139], v11, s[52:55], s26 offen sc1
    s_add_u32 s26, s26, 1024
    s_cmp_eq_u32 s26, s31
    s_cselect_b32 s26, s27, s26
    v_mfma_f32_16x16x32_bf16 v[148:151], v[116:119], a[108:111], v[148:151]
    ds_read_b64_tr_b16 v[106:107], v14 offset:5120
    v_mfma_f32_16x16x32_bf16 v[152:155], v[120:123], a[36:39], v[152:155]
    ds_read_b64_tr_b16 v[108:109], v15 offset:4096
    v_mfma_f32_16x16x32_bf16 v[156:159], v[120:123], a[108:111], v[156:159]
    s_waitcnt lgkmcnt(5)
    ds_read_b64_tr_b16 v[110:111], v15 offset:5120
    v_mfma_f32_16x16x32_bf16 v[160:163], v[124:127], a[36:39], v[160:163]
    ds_read_b64_tr_b16 v[112:113], v16 offset:4096
    v_mfma_f32_16x16x32_bf16 v[164:167], v[124:127], a[108:111], v[164:167]
    ds_read_b64_tr_b16 v[114:115], v16 offset:5120
    v_mfma_f32_16x16x32_bf16 v[168:171], v[128:131], a[36:39], v[168:171]
    ds_read_b64_tr_b16 v[116:117], v17 offset:4096
    v_mfma_f32_16x16x32_bf16 v[172:175], v[128:131], a[108:111], v[172:175]
    s_waitcnt lgkmcnt(5)
    ds_read_b64_tr_b16 v[118:119], v17 offset:5120
    v_mfma_f32_16x16x32_bf16 v[176:179], v[132:135], a[36:39], v[176:179]
    ds_read_b64_tr_b16 v[120:121], v252 offset:4096
    v_mfma_f32_16x16x32_bf16 v[180:183], v[132:135], a[108:111], v[180:183]
    s_waitcnt vmcnt(19)
    ds_read_b64_tr_b16 v[122:123], v252 offset:5120
    v_mfma_f32_16x16x32_bf16 v[136:139], v[104:107], a[40:43], v[136:139]
    ds_read_b64_tr_b16 v[124:125], v253 offset:4096
    buffer_load_dwordx4 a[68:71], v10, s[52:55], s26 offen sc1
    buffer_load_dwordx4 a[140:143], v11, s[52:55], s26 offen sc1
    v_mfma_f32_16x16x32_bf16 v[140:143], v[104:107], a[112:115], v[140:143]
    s_waitcnt lgkmcnt(5)
    ds_read_b64_tr_b16 v[126:127], v253 offset:5120
    v_mfma_f32_16x16x32_bf16 v[144:147], v[108:111], a[40:43], v[144:147]
    ds_read_b64_tr_b16 v[128:129], v14 offset:8192
    v_mfma_f32_16x16x32_bf16 v[148:151], v[108:111], a[112:115], v[148:151]
    ds_read_b64_tr_b16 v[130:131], v14 offset:9216
    v_mfma_f32_16x16x32_bf16 v[152:155], v[112:115], a[40:43], v[152:155]
    ds_read_b64_tr_b16 v[132:133], v15 offset:8192
    v_mfma_f32_16x16x32_bf16 v[156:159], v[112:115], a[112:115], v[156:159]
    s_waitcnt lgkmcnt(5)
    ds_read_b64_tr_b16 v[134:135], v15 offset:9216
    v_mfma_f32_16x16x32_bf16 v[160:163], v[116:119], a[40:43], v[160:163]
    ds_read_b64_tr_b16 v[104:105], v16 offset:8192
    v_mfma_f32_16x16x32_bf16 v[164:167], v[116:119], a[112:115], v[164:167]
    ds_read_b64_tr_b16 v[106:107], v16 offset:9216
    v_mfma_f32_16x16x32_bf16 v[168:171], v[120:123], a[40:43], v[168:171]
    ds_read_b64_tr_b16 v[108:109], v17 offset:8192
    v_mfma_f32_16x16x32_bf16 v[172:175], v[120:123], a[112:115], v[172:175]
    s_waitcnt lgkmcnt(5)
    ds_read_b64_tr_b16 v[110:111], v17 offset:9216
    v_mfma_f32_16x16x32_bf16 v[176:179], v[124:127], a[40:43], v[176:179]
    ds_read_b64_tr_b16 v[112:113], v252 offset:8192
    s_waitcnt vmcnt(8)
    v_cmp_ne_u64 vcc, v[20:21], v[24:25]
    s_and_b32 s12, vcc_lo, 0xffff
    s_cbranch_scc0 poll_5_ok
    s_mov_b32 s14, 0
poll_5:
    s_sleep 1
    buffer_load_dwordx2 v[20:21], v22, s[52:55], 0 offen offset:0 sc1
    s_add_u32 s14, s14, 1
    s_cmp_gt_u32 s14, 0x8000
    s_cbranch_scc1 poll_5_ok
    s_waitcnt vmcnt(0)
    v_cmp_ne_u64 vcc, v[20:21], v[24:25]
    s_and_b32 s12, vcc_lo, 0xffff
    s_cbranch_scc1 poll_5
poll_5_ok:

    v_mfma_f32_16x16x32_bf16 v[180:183], v[124:127], a[112:115], v[180:183]
    ds_read_b64_tr_b16 v[114:115], v252 offset:9216
    buffer_load_dwordx2 a[224:225], v81, s[52:55], 0 offen offset:0 sc1
    buffer_load_dwordx2 a[226:227], v81, s[52:55], 0 offen offset:128 sc1
    buffer_load_dwordx2 a[228:229], v81, s[52:55], 0 offen offset:256 sc1
    buffer_load_dwordx2 a[230:231], v81, s[52:55], 0 offen offset:384 sc1
    buffer_load_dwordx2 a[232:233], v81, s[52:55], 0 offen offset:512 sc1
    buffer_load_dwordx2 a[234:235], v81, s[52:55], 0 offen offset:640 sc1
    buffer_load_dwordx2 a[236:237], v81, s[52:55], 0 offen offset:768 sc1
    buffer_load_dwordx2 a[238:239], v81, s[52:55], 0 offen offset:896 sc1
    v_mfma_f32_16x16x32_bf16 v[136:139], v[128:131], a[44:47], v[136:139]
    ds_read_b64_tr_b16 v[116:117], v253 offset:8192
    s_add_u32 s12, s3, 0
    s_lshl_b32 s13, s12, 10
    s_add_u32 m0, s13, 147456
    s_add_u32 s12, s12, s18
    s_sub_u32 s13, s12, 18
    s_cmp_ge_u32 s12, 18
    s_cselect_b32 s12, s13, s12
    s_lshl_b32 s12, s12, 10
    s_add_u32 s12, s12, s30

    buffer_load_dwordx4 v10, s[52:55], s12 offen offset:0 sc1 lds
    v_mfma_f32_16x16x32_bf16 v[140:143], v[128:131], a[116:119], v[140:143]
    s_waitcnt lgkmcnt(5)
    ds_read_b64_tr_b16 v[118:119], v253 offset:9216
    v_mfma_f32_16x16x32_bf16 v[144:147], v[132:135], a[44:47], v[144:147]
    ds_read_b64_tr_b16 v[120:121], v14 offset:12288
    v_mfma_f32_16x16x32_bf16 v[148:151], v[132:135], a[116:119], v[148:151]
    ds_read_b64_tr_b16 v[122:123], v14 offset:13312
    v_mfma_f32_16x16x32_bf16 v[152:155], v[104:107], a[44:47], v[152:155]
    ds_read_b64_tr_b16 v[124:125], v15 offset:12288
    v_mfma_f32_16x16x32_bf16 v[156:159], v[104:107], a[116:119], v[156:159]
    s_waitcnt lgkmcnt(5)
    ds_read_b64_tr_b16 v[126:127], v15 offset:13312
    v_mfma_f32_16x16x32_bf16 v[160:163], v[108:111], a[44:47], v[160:163]
    ds_read_b64_tr_b16 v[128:129], v16 offset:12288
    v_mfma_f32_16x16x32_bf16 v[164:167], v[108:111], a[116:119], v[164:167]
    ds_read_b64_tr_b16 v[130:131], v16 offset:13312
    s_add_u32 s12, s3, 4
    s_lshl_b32 s13, s12, 10
    s_add_u32 m0, s13, 147456
    s_add_u32 s12, s12, s18
    s_sub_u32 s13, s12, 18
    s_cmp_ge_u32 s12, 18
    s_cselect_b32 s12, s13, s12
    s_lshl_b32 s12, s12, 10
    s_add_u32 s12, s12, s30

    buffer_load_dwordx4 v10, s[52:55], s12 offen offset:0 sc1 lds
    v_mfma_f32_16x16x32_bf16 v[168:171], v[112:115], a[44:47], v[168:171]
    ds_read_b64_tr_b16 v[132:133], v17 offset:12288
    v_mfma_f32_16x16x32_bf16 v[172:175], v[112:115], a[116:119], v[172:175]
    s_waitcnt lgkmcnt(5)
    ds_read_b64_tr_b16 v[134:135], v17 offset:13312
    v_mfma_f32_16x16x32_bf16 v[176:179], v[116:119], a[44:47], v[176:179]
    ds_read_b64_tr_b16 v[104:105], v252 offset:12288
    v_mfma_f32_16x16x32_bf16 v[180:183], v[116:119], a[116:119], v[180:183]
    ds_read_b64_tr_b16 v[106:107], v252 offset:13312
    v_mfma_f32_16x16x32_bf16 v[136:139], v[120:123], a[48:51], v[136:139]
    ds_read_b64_tr_b16 v[108:109], v253 offset:12288
    v_mfma_f32_16x16x32_bf16 v[140:143], v[120:123], a[120:123], v[140:143]
    s_waitcnt lgkmcnt(5)
    ds_read_b64_tr_b16 v[110:111], v253 offset:13312
    v_mfma_f32_16x16x32_bf16 v[144:147], v[124:127], a[48:51], v[144:147]
    ds_read_b64_tr_b16 v[112:113], v14 offset:16384
    v_mfma_f32_16x16x32_bf16 v[148:151], v[124:127], a[120:123], v[148:151]
    ds_read_b64_tr_b16 v[114:115], v14 offset:17408
    s_add_u32 s12, s3, 8
    s_lshl_b32 s13, s12, 10
    s_add_u32 m0, s13, 147456
    s_add_u32 s12, s12, s18
    s_sub_u32 s13, s12, 18
    s_cmp_ge_u32 s12, 18
    s_cselect_b32 s12, s13, s12
    s_lshl_b32 s12, s12, 10
    s_add_u32 s12, s12, s30

    buffer_load_dwordx4 v10, s[52:55], s12 offen offset:0 sc1 lds
    v_mfma_f32_16x16x32_bf16 v[152:155], v[128:131], a[48:51], v[152:155]
    ds_read_b64_tr_b16 v[116:117], v15 offset:16384
    v_mfma_f32_16x16x32_bf16 v[156:159], v[128:131], a[120:123], v[156:159]
    s_waitcnt lgkmcnt(5)
    ds_read_b64_tr_b16 v[118:119], v15 offset:17408
    v_mfma_f32_16x16x32_bf16 v[160:163], v[132:135], a[48:51], v[160:163]
    ds_read_b64_tr_b16 v[120:121], v16 offset:16384
    v_mfma_f32_16x16x32_bf16 v[164:167], v[132:135], a[120:123], v[164:167]
    ds_read_b64_tr_b16 v[122:123], v16 offset:17408
    v_mfma_f32_16x16x32_bf16 v[168:171], v[104:107], a[48:51], v[168:171]
    ds_read_b64_tr_b16 v[124:125], v17 offset:16384
    v_mfma_f32_16x16x32_bf16 v[172:175], v[104:107], a[120:123], v[172:175]
    s_waitcnt lgkmcnt(5)
    ds_read_b64_tr_b16 v[126:127], v17 offset:17408
    v_mfma_f32_16x16x32_bf16 v[176:179], v[108:111], a[48:51], v[176:179]
    ds_read_b64_tr_b16 v[128:129], v252 offset:16384
    s_add_u32 s12, s3, 12
    s_lshl_b32 s13, s12, 10
    s_add_u32 m0, s13, 147456
    s_add_u32 s12, s12, s18
    s_sub_u32 s13, s12, 18
    s_cmp_ge_u32 s12, 18
    s_cselect_b32 s12, s13, s12
    s_lshl_b32 s12, s12, 10
    s_add_u32 s12, s12, s30

    buffer_load_dwordx4 v10, s[52:55], s12 offen offset:0 sc1 lds
    v_mfma_f32_16x16x32_bf16 v[180:183], v[108:111], a[120:123], v[180:183]
    ds_read_b64_tr_b16 v[130:131], v252 offset:17408
    v_mfma_f32_16x16x32_bf16 v[136:139], v[112:115], a[52:55], v[136:139]
    ds_read_b64_tr_b16 v[132:133], v253 offset:16384
    v_mfma_f32_16x16x32_bf16 v[140:143], v[112:115], a[124:127], v[140:143]
    s_waitcnt lgkmcnt(5)
    ds_read_b64_tr_b16 v[134:135], v253 offset:17408
    v_mfma_f32_16x16x32_bf16 v[144:147], v[116:119], a[52:55], v[144:147]
    ds_read_b64_tr_b16 v[104:105], v14 offset:20480
    v_mfma_f32_16x16x32_bf16 v[148:151], v[116:119], a[124:127], v[148:151]
    ds_read_b64_tr_b16 v[106:107], v14 offset:21504
    v_mfma_f32_16x16x32_bf16 v[152:155], v[120:123], a[52:55], v[152:155]
    ds_read_b64_tr_b16 v[108:109], v15 offset:20480
    v_mfma_f32_16x16x32_bf16 v[156:159], v[120:123], a[124:127], v[156:159]
    s_waitcnt lgkmcnt(5)
    ds_read_b64_tr_b16 v[110:111], v15 offset:21504
    v_mfma_f32_16x16x32_bf16 v[160:163], v[124:127], a[52:55], v[160:163]
    ds_read_b64_tr_b16 v[112:113], v16 offset:20480
    v_mfma_f32_16x16x32_bf16 v[164:167], v[124:127], a[124:127], v[164:167]
    ds_read_b64_tr_b16 v[114:115], v16 offset:21504
    v_mfma_f32_16x16x32_bf16 v[168:171], v[128:131], a[52:55], v[168:171]
    ds_read_b64_tr_b16 v[116:117], v17 offset:20480
    s_lshl_b32 s12, s5, 2
    s_add_u32 s12, s12, s3
    s_mul_i32 s12, s12, 41
    v_min_u32 v29, 40, v0
    v_add_u32 v29, s12, v29
    v_min_u32 v29, 5183, v29
    v_lshlrev_b32 v29, 7, v29
    s_add_u32 s12, s0, 5120

    buffer_load_dword v83, v29, s[48:51], s0 offen
    v_mfma_f32_16x16x32_bf16 v[172:175], v[128:131], a[124:127], v[172:175]
    s_waitcnt lgkmcnt(5)
    ds_read_b64_tr_b16 v[118:119], v17 offset:21504
    v_mfma_f32_16x16x32_bf16 v[176:179], v[132:135], a[52:55], v[176:179]
    ds_read_b64_tr_b16 v[120:121], v252 offset:20480
    v_mfma_f32_16x16x32_bf16 v[180:183], v[132:135], a[124:127], v[180:183]
    s_waitcnt vmcnt(19)
    ds_read_b64_tr_b16 v[122:123], v252 offset:21504
    v_mfma_f32_16x16x32_bf16 v[136:139], v[104:107], a[56:59], v[136:139]
    ds_read_b64_tr_b16 v[124:125], v253 offset:20480
    v_mfma_f32_16x16x32_bf16 v[140:143], v[104:107], a[128:131], v[140:143]
    s_waitcnt lgkmcnt(5)
    ds_read_b64_tr_b16 v[126:127], v253 offset:21504
    v_add_f32 v88, v88, v90
    v_add_f32 v89, v89, v91
    v_mfma_f32_16x16x32_bf16 v[144:147], v[108:111], a[56:59], v[144:147]
    ds_read_b64_tr_b16 v[128:129], v14 offset:24576
    v_add_f32 v88, v88, v92
    v_add_f32 v89, v89, v93
    v_mfma_f32_16x16x32_bf16 v[148:151], v[108:111], a[128:131], v[148:151]
    ds_read_b64_tr_b16 v[130:131], v14 offset:25600
    v_mov_b32 v90, v88
    s_nop 1
    v_permlane16_swap_b32 v88, v90
    v_mfma_f32_16x16x32_bf16 v[152:155], v[112:115], a[56:59], v[152:155]
    ds_read_b64_tr_b16 v[132:133], v15 offset:24576
    s_nop 1
    v_add_f32 v88, v88, v90
    v_mfma_f32_16x16x32_bf16 v[156:159], v[112:115], a[128:131], v[156:159]
    s_waitcnt lgkmcnt(5)
    ds_read_b64_tr_b16 v[134:135], v15 offset:25600
    v_mov_b32 v90, v88
    s_nop 1
    v_mfma_f32_16x16x32_bf16 v[160:163], v[116:119], a[56:59], v[160:163]
    ds_read_b64_tr_b16 v[104:105], v16 offset:24576
    v_permlane32_swap_b32 v88, v90
    s_nop 1
    v_mfma_f32_16x16x32_bf16 v[164:167], v[116:119], a[128:131], v[164:167]
    ds_read_b64_tr_b16 v[106:107], v16 offset:25600
    v_add_f32 v88, v88, v90
    v_mov_b32 v90, v89
    s_nop 1
    v_mfma_f32_16x16x32_bf16 v[168:171], v[120:123], a[56:59], v[168:171]
    ds_read_b64_tr_b16 v[108:109], v17 offset:24576
    v_permlane16_swap_b32 v89, v90
    s_nop 1
    v_mfma_f32_16x16x32_bf16 v[172:175], v[120:123], a[128:131], v[172:175]
    s_waitcnt lgkmcnt(5)
    ds_read_b64_tr_b16 v[110:111], v17 offset:25600
    v_add_f32 v89, v89, v90
    v_mov_b32 v90, v89
    v_mfma_f32_16x16x32_bf16 v[176:179], v[124:127], a[56:59], v[176:179]
    ds_read_b64_tr_b16 v[112:113], v252 offset:24576
    s_nop 1
    v_permlane32_swap_b32 v89, v90
    s_nop 1
    v_mfma_f32_16x16x32_bf16 v[180:183], v[124:127], a[128:131], v[180:183]
    s_waitcnt vmcnt(17)
    ds_read_b64_tr_b16 v[114:115], v252 offset:25600
    v_add_f32 v89, v89, v90
    v_mul_f32 v90, 0x3ae38e39, v88
    v_mfma_f32_16x16x32_bf16 v[136:139], v[128:131], a[60:63], v[136:139]
    ds_read_b64_tr_b16 v[116:117], v253 offset:24576
    v_mul_f32 v91, 0x3ae38e39, v89
    v_fma_f32 v91, -v90, v90, v91
    v_mfma_f32_16x16x32_bf16 v[140:143], v[128:131], a[132:135], v[140:143]
    s_waitcnt lgkmcnt(5)
    ds_read_b64_tr_b16 v[118:119], v253 offset:25600
    v_max_f32 v91, 0, v91
    v_cvt_pk_bf16_f32 v91, v91, v90
    v_mfma_f32_16x16x32_bf16 v[144:147], v[132:135], a[60:63], v[144:147]
    ds_read_b64_tr_b16 v[120:121], v14 offset:28672
    v_and_b32 v90, 0xffff0000, v91
    v_lshlrev_b32 v91, 16, v91
    v_add_f32 v91, 0x3727c5ac, v91
    v_mfma_f32_16x16x32_bf16 v[148:151], v[132:135], a[132:135], v[148:151]
    ds_read_b64_tr_b16 v[122:123], v14 offset:29696
    v_cvt_pk_bf16_f32 v91, v91, v91
    v_lshlrev_b32 v91, 16, v91
    v_mfma_f32_16x16x32_bf16 v[152:155], v[104:107], a[60:63], v[152:155]
    ds_read_b64_tr_b16 v[124:125], v15 offset:28672
    v_sqrt_f32 v91, v91
    v_mfma_f32_16x16x32_bf16 v[156:159], v[104:107], a[132:135], v[156:159]
    s_waitcnt lgkmcnt(5)
    ds_read_b64_tr_b16 v[126:127], v15 offset:29696
    s_nop 0
    v_cvt_pk_bf16_f32 v91, v91, v91
    v_lshlrev_b32 v46, 16, v91
    v_mfma_f32_16x16x32_bf16 v[160:163], v[108:111], a[60:63], v[160:163]
    ds_read_b64_tr_b16 v[128:129], v16 offset:28672
    v_rcp_f32 v91, v46
    v_mfma_f32_16x16x32_bf16 v[164:167], v[108:111], a[132:135], v[164:167]
    ds_read_b64_tr_b16 v[130:131], v16 offset:29696
    v_cvt_pk_bf16_f32 v52, -v90, -v90
    v_cmp_eq_u32 vcc, 0, v1
    v_mfma_f32_16x16x32_bf16 v[168:171], v[112:115], a[60:63], v[168:171]
    ds_read_b64_tr_b16 v[132:133], v17 offset:28672
    v_mov_b32 v55, 0
    v_mov_b32 v54, 0
    v_mfma_f32_16x16x32_bf16 v[172:175], v[112:115], a[132:135], v[172:175]
    s_waitcnt lgkmcnt(5)
    ds_read_b64_tr_b16 v[134:135], v17 offset:29696
    v_cndmask_b32 v52, 0, v52, vcc
    v_mov_b32 v53, v52
    v_mul_f32 v44, 0xc0135761, v91
    v_mfma_f32_16x16x32_bf16 v[176:179], v[116:119], a[60:63], v[176:179]
    ds_read_b64_tr_b16 v[104:105], v252 offset:28672
    v_mul_f32 v92, v91, v91
    v_mul_f32 v92, v92, v91
    v_mfma_f32_16x16x32_bf16 v[180:183], v[116:119], a[132:135], v[180:183]
    s_waitcnt vmcnt(15)
    ds_read_b64_tr_b16 v[106:107], v252 offset:29696
    v_mul_f32 v45, 0xbdd2d3e8, v92
    v_add_f32 v96, v96, v98
    v_mfma_f32_16x16x32_bf16 v[136:139], v[120:123], a[64:67], v[136:139]
    ds_read_b64_tr_b16 v[108:109], v253 offset:28672
    v_add_f32 v97, v97, v99
    v_add_f32 v96, v96, v100
    v_add_f32 v97, v97, v101
    v_mfma_f32_16x16x32_bf16 v[140:143], v[120:123], a[136:139], v[140:143]
    s_waitcnt lgkmcnt(5)
    ds_read_b64_tr_b16 v[110:111], v253 offset:29696
    v_mov_b32 v98, v96
    s_nop 1
    v_mfma_f32_16x16x32_bf16 v[144:147], v[124:127], a[64:67], v[144:147]
    ds_read_b64_tr_b16 v[112:113], v14 offset:32768
    v_permlane16_swap_b32 v96, v98
    s_nop 1
    v_mfma_f32_16x16x32_bf16 v[148:151], v[124:127], a[136:139], v[148:151]
    ds_read_b64_tr_b16 v[114:115], v14 offset:33792
    v_add_f32 v96, v96, v98
    v_mov_b32 v98, v96
    v_mfma_f32_16x16x32_bf16 v[152:155], v[128:131], a[64:67], v[152:155]
    ds_read_b64_tr_b16 v[116:117], v15 offset:32768
    s_nop 1
    v_permlane32_swap_b32 v96, v98
    s_nop 1
    v_mfma_f32_16x16x32_bf16 v[156:159], v[128:131], a[136:139], v[156:159]
    s_waitcnt lgkmcnt(5)
    ds_read_b64_tr_b16 v[118:119], v15 offset:33792
    v_add_f32 v96, v96, v98
    v_mov_b32 v98, v97
    v_mfma_f32_16x16x32_bf16 v[160:163], v[132:135], a[64:67], v[160:163]
    ds_read_b64_tr_b16 v[120:121], v16 offset:32768
    s_nop 1
    v_permlane16_swap_b32 v97, v98
    v_mfma_f32_16x16x32_bf16 v[164:167], v[132:135], a[136:139], v[164:167]
    ds_read_b64_tr_b16 v[122:123], v16 offset:33792
    s_nop 1
    v_add_f32 v97, v97, v98
    v_mov_b32 v98, v97
    v_mfma_f32_16x16x32_bf16 v[168:171], v[104:107], a[64:67], v[168:171]
    ds_read_b64_tr_b16 v[124:125], v17 offset:32768
    s_nop 1
    v_permlane32_swap_b32 v97, v98
    v_mfma_f32_16x16x32_bf16 v[172:175], v[104:107], a[136:139], v[172:175]
    s_waitcnt lgkmcnt(5)
    ds_read_b64_tr_b16 v[126:127], v17 offset:33792
    s_nop 1
    v_add_f32 v97, v97, v98
    v_mfma_f32_16x16x32_bf16 v[176:179], v[108:111], a[64:67], v[176:179]
    ds_read_b64_tr_b16 v[128:129], v252 offset:32768
    v_mul_f32 v98, 0x3ae38e39, v96
    v_mul_f32 v99, 0x3ae38e39, v97
    v_mfma_f32_16x16x32_bf16 v[180:183], v[108:111], a[136:139], v[180:183]
    s_waitcnt vmcnt(13)
    ds_read_b64_tr_b16 v[130:131], v252 offset:33792
    v_fma_f32 v99, -v98, v98, v99
    v_max_f32 v99, 0, v99
    v_cvt_pk_bf16_f32 v99, v99, v98
    v_mfma_f32_16x16x32_bf16 v[136:139], v[112:115], a[68:71], v[136:139]
    ds_read_b64_tr_b16 v[132:133], v253 offset:32768
    v_and_b32 v98, 0xffff0000, v99
    v_lshlrev_b32 v99, 16, v99
    v_mfma_f32_16x16x32_bf16 v[140:143], v[112:115], a[140:143], v[140:143]
    s_waitcnt lgkmcnt(5)
    ds_read_b64_tr_b16 v[134:135], v253 offset:33792
    v_add_f32 v99, 0x3727c5ac, v99
    v_cvt_pk_bf16_f32 v99, v99, v99
    v_mfma_f32_16x16x32_bf16 v[144:147], v[116:119], a[68:71], v[144:147]
    v_lshlrev_b32 v99, 16, v99
    v_sqrt_f32 v99, v99
    v_mfma_f32_16x16x32_bf16 v[148:151], v[116:119], a[140:143], v[148:151]
    s_nop 0
    v_cvt_pk_bf16_f32 v99, v99, v99
    v_mfma_f32_16x16x32_bf16 v[152:155], v[120:123], a[68:71], v[152:155]
    v_lshlrev_b32 v50, 16, v99
    v_rcp_f32 v99, v50
    v_mfma_f32_16x16x32_bf16 v[156:159], v[120:123], a[140:143], v[156:159]
    s_waitcnt lgkmcnt(2)
    v_cvt_pk_bf16_f32 v56, -v98, -v98
    v_mfma_f32_16x16x32_bf16 v[160:163], v[124:127], a[68:71], v[160:163]
    v_cmp_eq_u32 vcc, 0, v1
    v_mov_b32 v59, 0
    v_mov_b32 v58, 0
    v_mfma_f32_16x16x32_bf16 v[164:167], v[124:127], a[140:143], v[164:167]
    v_cndmask_b32 v56, 0, v56, vcc
    v_mov_b32 v57, v56
    v_mfma_f32_16x16x32_bf16 v[168:171], v[128:131], a[68:71], v[168:171]
    v_mul_f32 v48, 0xc0135761, v99
    v_mul_f32 v100, v99, v99
    v_mfma_f32_16x16x32_bf16 v[172:175], v[128:131], a[140:143], v[172:175]
    s_waitcnt lgkmcnt(0)
    v_mul_f32 v100, v100, v99
    v_mul_f32 v49, 0xbdd2d3e8, v100
    v_mfma_f32_16x16x32_bf16 v[176:179], v[132:135], a[68:71], v[176:179]
    v_min_u32 v22, 7, v0
    v_lshlrev_b32 v22, 3, v22
    v_mfma_f32_16x16x32_bf16 v[180:183], v[132:135], a[140:143], v[180:183]
    v_add_u32 v22, s10, v22
    s_waitcnt vmcnt(5)
    v_accvgpr_read_b32 v60, a224
    v_accvgpr_read_b32 v61, a225
    v_accvgpr_read_b32 v64, a226
    v_accvgpr_read_b32 v65, a227
    v_mfma_f32_16x16x32_bf16 v[136:139], v[60:63], v[52:55], v[136:139]
    v_mfma_f32_16x16x32_bf16 v[140:143], v[60:63], v[56:59], v[140:143]
    v_accvgpr_read_b32 v60, a228
    v_accvgpr_read_b32 v61, a229
    v_mfma_f32_16x16x32_bf16 v[144:147], v[64:67], v[52:55], v[144:147]
    v_mfma_f32_16x16x32_bf16 v[148:151], v[64:67], v[56:59], v[148:151]
    v_accvgpr_read_b32 v64, a230
    v_accvgpr_read_b32 v65, a231
    v_mfma_f32_16x16x32_bf16 v[152:155], v[60:63], v[52:55], v[152:155]
    v_mfma_f32_16x16x32_bf16 v[156:159], v[60:63], v[56:59], v[156:159]
    v_accvgpr_read_b32 v60, a232
    v_accvgpr_read_b32 v61, a233
    v_mfma_f32_16x16x32_bf16 v[160:163], v[64:67], v[52:55], v[160:163]
    v_mfma_f32_16x16x32_bf16 v[164:167], v[64:67], v[56:59], v[164:167]
    v_accvgpr_read_b32 v64, a234
    v_accvgpr_read_b32 v65, a235
    v_mfma_f32_16x16x32_bf16 v[168:171], v[60:63], v[52:55], v[168:171]
    v_mfma_f32_16x16x32_bf16 v[172:175], v[60:63], v[56:59], v[172:175]
    v_mfma_f32_16x16x32_bf16 v[176:179], v[64:67], v[52:55], v[176:179]
    v_mfma_f32_16x16x32_bf16 v[180:183], v[64:67], v[56:59], v[180:183]
    v_add_u32 v14, 36864, v254
    v_add_u32 v15, 36864, v255
    v_mov_b32 v228, v18
    v_mov_b32 v229, v18
    v_mov_b32 v230, v18
    v_mov_b32 v231, v18
    s_waitcnt vmcnt(1)
    s_barrier
    ds_read_b64_tr_b16 v[104:105], v254 offset:0
    ds_read_b64_tr_b16 v[106:107], v254 offset:1024
    ds_read_b64_tr_b16 v[108:109], v255 offset:0
    ds_read_b64_tr_b16 v[110:111], v255 offset:1024
    ds_read_b64_tr_b16 v[112:113], v13 offset:0
    ds_read_b64_tr_b16 v[114:115], v13 offset:256
    ds_read_b64_tr_b16 v[116:117], v254 offset:4096
    ds_read_b64_tr_b16 v[118:119], v254 offset:5120
    ds_read_b64_tr_b16 v[120:121], v255 offset:4096
    ds_read_b64_tr_b16 v[122:123], v255 offset:5120
    s_waitcnt lgkmcnt(8)
    v_mfma_f32_16x16x32_bf16 v[184:187], v[104:107], a[0:3], 0
    ds_read_b64_tr_b16 v[124:125], v13 offset:1024
    v_mul_f32 v208, v136, v136
    v_mul_f32 v209, v137, v137
    v_mul_f32 v210, v138, v138
    v_mul_f32 v211, v139, v139
    v_mul_f32 v212, v144, v144
    s_add_u32 s21, s88, 0
    s_mov_b32 s13, 0
    s_add_u32 s12, s88, 1
    s_cmp_ge_u32 s3, 1
    s_cselect_b32 s21, s12, s21
    s_cselect_b32 s13, 9472, s13
    s_add_u32 s12, s88, 2
    s_cmp_ge_u32 s3, 2
    s_cselect_b32 s21, s12, s21
    s_cselect_b32 s13, 18944, s13
    s_add_u32 s12, s88, 3
    s_cmp_ge_u32 s3, 3
    s_cselect_b32 s21, s12, s21
    s_cselect_b32 s13, 28416, s13
    s_mov_b32 m0, s13
    s_mul_i32 s20, s21, 36864
    s_add_u32 s20, s20, s0
    buffer_load_dwordx4 v68, s[48:51], s20 offen offset:0 lds
    v_mfma_f32_16x16x32_bf16 v[188:191], v[104:107], a[72:75], 0
    s_waitcnt lgkmcnt(5)
    ds_read_b64_tr_b16 v[126:127], v13 offset:1280
    v_mul_f32 v213, v145, v145
    v_mul_f32 v214, v146, v146
    v_mul_f32 v215, v147, v147
    v_fma_f32 v208, v208, v45, v44
    v_mfma_f32_16x16x32_bf16 v[192:195], v[108:111], a[0:3], 0
    ds_read_b64_tr_b16 v[128:129], v254 offset:8192
    v_fma_f32 v209, v209, v45, v44
    v_fma_f32 v210, v210, v45, v44
    v_fma_f32 v211, v211, v45, v44
    v_fma_f32 v212, v212, v45, v44
    v_mfma_f32_16x16x32_bf16 v[196:199], v[108:111], a[72:75], 0
    ds_read_b64_tr_b16 v[130:131], v254 offset:9216
    v_fma_f32 v213, v213, v45, v44
    v_fma_f32 v214, v214, v45, v44
    v_fma_f32 v215, v215, v45, v44
    v_mul_f32 v208, v136, v208
    v_mul_f32 v209, v137, v209
    v_mfma_f32_16x16x32_bf16 v[248:251], v[228:231], v[112:115], 0
    ds_read_b64_tr_b16 v[132:133], v255 offset:8192
    v_mul_f32 v210, v138, v210
    v_mul_f32 v211, v139, v211
    v_mul_f32 v212, v144, v212
    v_mul_f32 v213, v145, v213
    v_mfma_f32_16x16x32_bf16 v[200:203], v[112:115], a[0:3], 0
    ds_read_b64_tr_b16 v[134:135], v255 offset:9216
    v_mul_f32 v214, v146, v214
    v_mul_f32 v215, v147, v215
    v_exp_f32 v208, v208
    buffer_load_dwordx4 v69, s[48:51], s20 offen offset:1056 lds
    v_mfma_f32_16x16x32_bf16 v[204:207], v[112:115], a[72:75], 0
    s_waitcnt lgkmcnt(6)
    v_exp_f32 v209, v209
    v_exp_f32 v210, v210
    v_mfma_f32_16x16x32_bf16 v[184:187], v[116:119], a[4:7], v[184:187]
    ds_read_b64_tr_b16 v[104:105], v13 offset:2048
    v_exp_f32 v211, v211
    v_exp_f32 v212, v212
    v_exp_f32 v213, v213
    v_mfma_f32_16x16x32_bf16 v[188:191], v[116:119], a[76:79], v[188:191]
    ds_read_b64_tr_b16 v[106:107], v13 offset:2304
    v_exp_f32 v214, v214
    v_exp_f32 v215, v215
    v_mfma_f32_16x16x32_bf16 v[192:195], v[120:123], a[4:7], v[192:195]
    ds_read_b64_tr_b16 v[108:109], v254 offset:12288
    v_fma_f32 v208, v208, v46, v46
    v_fma_f32 v209, v209, v46, v46
    v_fma_f32 v210, v210, v46, v46
    v_mfma_f32_16x16x32_bf16 v[196:199], v[120:123], a[76:79], v[196:199]
    s_waitcnt lgkmcnt(5)
    ds_read_b64_tr_b16 v[110:111], v254 offset:13312
    v_fma_f32 v211, v211, v46, v46
    v_fma_f32 v212, v212, v46, v46
    v_fma_f32 v213, v213, v46, v46
    v_fma_f32 v214, v214, v46, v46
    v_mfma_f32_16x16x32_bf16 v[248:251], v[228:231], v[124:127], v[248:251]
    ds_read_b64_tr_b16 v[112:113], v255 offset:12288
    v_fma_f32 v215, v215, v46, v46
    v_rcp_f32 v208, v208
    v_rcp_f32 v209, v209
    buffer_load_dwordx4 v70, s[48:51], s20 offen offset:2112 lds
    v_mfma_f32_16x16x32_bf16 v[200:203], v[124:127], a[4:7], v[200:203]
    ds_read_b64_tr_b16 v[114:115], v255 offset:13312
    v_rcp_f32 v210, v210
    v_rcp_f32 v211, v211
    v_mfma_f32_16x16x32_bf16 v[204:207], v[124:127], a[76:79], v[204:207]
    v_rcp_f32 v212, v212
    v_rcp_f32 v213, v213
    v_mfma_f32_16x16x32_bf16 v[184:187], v[128:131], a[8:11], v[184:187]
    ds_read_b64_tr_b16 v[116:117], v13 offset:3072
    v_rcp_f32 v214, v214
    v_rcp_f32 v215, v215
    v_mul_f32 v136, v136, v208
    v_mfma_f32_16x16x32_bf16 v[188:191], v[128:131], a[80:83], v[188:191]
    s_waitcnt lgkmcnt(5)
    ds_read_b64_tr_b16 v[118:119], v13 offset:3328
    v_mul_f32 v137, v137, v209
    v_mul_f32 v138, v138, v210
    v_mul_f32 v139, v139, v211
    v_mul_f32 v144, v144, v212
    v_mfma_f32_16x16x32_bf16 v[192:195], v[132:135], a[8:11], v[192:195]
    ds_read_b64_tr_b16 v[120:121], v254 offset:16384
    v_mul_f32 v145, v145, v213
    v_mul_f32 v146, v146, v214
    v_mul_f32 v147, v147, v215
    v_cvt_pk_bf16_f32 v88, v136, v137
    v_mfma_f32_16x16x32_bf16 v[196:199], v[132:135], a[80:83], v[196:199]
    ds_read_b64_tr_b16 v[122:123], v254 offset:17408
    v_cvt_pk_bf16_f32 v89, v138, v139
    v_cvt_pk_bf16_f32 v90, v144, v145
    v_cvt_pk_bf16_f32 v91, v146, v147
    buffer_store_dwordx4 v[88:91], v10, s[52:55], s92 offen offset:0 sc1
    buffer_load_dwordx4 v71, s[48:51], s20 offen offset:3168 lds
    v_mfma_f32_16x16x32_bf16 v[248:251], v[228:231], v[104:107], v[248:251]
    ds_read_b64_tr_b16 v[124:125], v255 offset:16384
    v_mul_f32 v216, v140, v140
    v_mul_f32 v217, v141, v141
    v_mul_f32 v218, v142, v142
    v_mfma_f32_16x16x32_bf16 v[200:203], v[104:107], a[8:11], v[200:203]
    ds_read_b64_tr_b16 v[126:127], v255 offset:17408
    v_mul_f32 v219, v143, v143
    v_mul_f32 v220, v148, v148
    v_mul_f32 v221, v149, v149
    v_mul_f32 v222, v150, v150
    v_mfma_f32_16x16x32_bf16 v[204:207], v[104:107], a[80:83], v[204:207]
    s_waitcnt lgkmcnt(6)
    v_mul_f32 v223, v151, v151
    v_fma_f32 v216, v216, v49, v48
    v_fma_f32 v217, v217, v49, v48
    v_fma_f32 v218, v218, v49, v48
    v_mfma_f32_16x16x32_bf16 v[184:187], v[108:111], a[12:15], v[184:187]
    ds_read_b64_tr_b16 v[128:129], v13 offset:4096
    v_fma_f32 v219, v219, v49, v48
    v_fma_f32 v220, v220, v49, v48
    v_fma_f32 v221, v221, v49, v48
    v_fma_f32 v222, v222, v49, v48
    v_mfma_f32_16x16x32_bf16 v[188:191], v[108:111], a[84:87], v[188:191]
    ds_read_b64_tr_b16 v[130:131], v13 offset:4352
    v_fma_f32 v223, v223, v49, v48
    v_mul_f32 v216, v140, v216
    v_mul_f32 v217, v141, v217
    v_mul_f32 v218, v142, v218
    v_mul_f32 v219, v143, v219
    v_mfma_f32_16x16x32_bf16 v[192:195], v[112:115], a[12:15], v[192:195]
    ds_read_b64_tr_b16 v[132:133], v254 offset:20480
    v_mul_f32 v220, v148, v220
    v_mul_f32 v221, v149, v221
    v_mul_f32 v222, v150, v222
    v_mul_f32 v223, v151, v223
    s_add_u32 m0, m0, 4224
    s_add_u32 s20, s20, 4608
    buffer_load_dwordx4 v68, s[48:51], s20 offen offset:0 lds
    v_mfma_f32_16x16x32_bf16 v[196:199], v[112:115], a[84:87], v[196:199]
    s_waitcnt lgkmcnt(5)
    ds_read_b64_tr_b16 v[134:135], v254 offset:21504
    v_exp_f32 v216, v216
    v_exp_f32 v217, v217
    v_mfma_f32_16x16x32_bf16 v[248:251], v[228:231], v[116:119], v[248:251]
    ds_read_b64_tr_b16 v[104:105], v255 offset:20480
    v_exp_f32 v218, v218
    v_exp_f32 v219, v219
    v_exp_f32 v220, v220
    v_mfma_f32_16x16x32_bf16 v[200:203], v[116:119], a[12:15], v[200:203]
    ds_read_b64_tr_b16 v[106:107], v255 offset:21504
    v_exp_f32 v221, v221
    v_exp_f32 v222, v222
    v_mfma_f32_16x16x32_bf16 v[204:207], v[116:119], a[84:87], v[204:207]
    v_exp_f32 v223, v223
    v_fma_f32 v216, v216, v50, v50
    v_mfma_f32_16x16x32_bf16 v[184:187], v[120:123], a[16:19], v[184:187]
    ds_read_b64_tr_b16 v[108:109], v13 offset:5120
    v_fma_f32 v217, v217, v50, v50
    v_fma_f32 v218, v218, v50, v50
    v_fma_f32 v219, v219, v50, v50
    v_fma_f32 v220, v220, v50, v50
    v_mfma_f32_16x16x32_bf16 v[188:191], v[120:123], a[88:91], v[188:191]
    s_waitcnt lgkmcnt(5)
    ds_read_b64_tr_b16 v[110:111], v13 offset:5376
    v_fma_f32 v221, v221, v50, v50
    v_fma_f32 v222, v222, v50, v50
    v_fma_f32 v223, v223, v50, v50
    v_rcp_f32 v216, v216
    buffer_load_dwordx4 v69, s[48:51], s20 offen offset:1056 lds
    v_mfma_f32_16x16x32_bf16 v[192:195], v[124:127], a[16:19], v[192:195]
    ds_read_b64_tr_b16 v[112:113], v254 offset:24576
    v_rcp_f32 v217, v217
    v_rcp_f32 v218, v218
    v_mfma_f32_16x16x32_bf16 v[196:199], v[124:127], a[88:91], v[196:199]
    ds_read_b64_tr_b16 v[114:115], v254 offset:25600
    v_rcp_f32 v219, v219
    v_rcp_f32 v220, v220
    v_mfma_f32_16x16x32_bf16 v[248:251], v[228:231], v[128:131], v[248:251]
    ds_read_b64_tr_b16 v[116:117], v255 offset:24576
    v_rcp_f32 v221, v221
    v_rcp_f32 v222, v222
    v_mfma_f32_16x16x32_bf16 v[200:203], v[128:131], a[16:19], v[200:203]
    ds_read_b64_tr_b16 v[118:119], v255 offset:25600
    v_rcp_f32 v223, v223
    v_mul_f32 v140, v140, v216
    v_mul_f32 v141, v141, v217
    v_mul_f32 v142, v142, v218
    v_mfma_f32_16x16x32_bf16 v[204:207], v[128:131], a[88:91], v[204:207]
    s_waitcnt lgkmcnt(6)
    v_mul_f32 v143, v143, v219
    v_mul_f32 v148, v148, v220
    v_mul_f32 v149, v149, v221
    v_mul_f32 v150, v150, v222
    v_mfma_f32_16x16x32_bf16 v[184:187], v[132:135], a[20:23], v[184:187]
    ds_read_b64_tr_b16 v[120:121], v13 offset:6144
    v_mul_f32 v151, v151, v223
    v_cvt_pk_bf16_f32 v92, v140, v141
    v_cvt_pk_bf16_f32 v93, v142, v143
    v_cvt_pk_bf16_f32 v94, v148, v149
    buffer_load_dwordx4 v70, s[48:51], s20 offen offset:2112 lds
    v_mfma_f32_16x16x32_bf16 v[188:191], v[132:135], a[92:95], v[188:191]
    ds_read_b64_tr_b16 v[122:123], v13 offset:6400
    v_cvt_pk_bf16_f32 v95, v150, v151
    buffer_store_dwordx4 v[92:95], v12, s[52:55], s92 offen offset:0 sc1
    v_mfma_f32_16x16x32_bf16 v[192:195], v[104:107], a[20:23], v[192:195]
    ds_read_b64_tr_b16 v[124:125], v254 offset:28672
    v_mul_f32 v208, v152, v152
    v_mul_f32 v209, v153, v153
    v_mul_f32 v210, v154, v154
    v_mul_f32 v211, v155, v155
    v_mul_f32 v212, v160, v160
    v_mfma_f32_16x16x32_bf16 v[196:199], v[104:107], a[92:95], v[196:199]
    s_waitcnt lgkmcnt(5)
    ds_read_b64_tr_b16 v[126:127], v254 offset:29696
    v_mul_f32 v213, v161, v161
    v_mul_f32 v214, v162, v162
    v_mul_f32 v215, v163, v163
    v_fma_f32 v208, v208, v45, v44
    v_mfma_f32_16x16x32_bf16 v[248:251], v[228:231], v[108:111], v[248:251]
    ds_read_b64_tr_b16 v[128:129], v255 offset:28672
    v_fma_f32 v209, v209, v45, v44
    v_fma_f32 v210, v210, v45, v44
    v_fma_f32 v211, v211, v45, v44
    v_fma_f32 v212, v212, v45, v44
    v_mfma_f32_16x16x32_bf16 v[200:203], v[108:111], a[20:23], v[200:203]
    ds_read_b64_tr_b16 v[130:131], v255 offset:29696
    v_fma_f32 v213, v213, v45, v44
    v_fma_f32 v214, v214, v45, v44
    v_fma_f32 v215, v215, v45, v44
    v_mul_f32 v208, v152, v208
    v_mul_f32 v209, v153, v209
    v_mfma_f32_16x16x32_bf16 v[204:207], v[108:111], a[92:95], v[204:207]
    v_mul_f32 v210, v154, v210
    v_mul_f32 v211, v155, v211
    v_mul_f32 v212, v160, v212
    v_mul_f32 v213, v161, v213
    buffer_load_dwordx4 v71, s[48:51], s20 offen offset:3168 lds
    v_mfma_f32_16x16x32_bf16 v[184:187], v[112:115], a[24:27], v[184:187]
    ds_read_b64_tr_b16 v[132:133], v13 offset:7168
    v_mul_f32 v214, v162, v214
    v_mul_f32 v215, v163, v215
    v_exp_f32 v208, v208
    v_mfma_f32_16x16x32_bf16 v[188:191], v[112:115], a[96:99], v[188:191]
    s_waitcnt lgkmcnt(5)
    ds_read_b64_tr_b16 v[134:135], v13 offset:7424
    v_exp_f32 v209, v209
    v_exp_f32 v210, v210
    v_mfma_f32_16x16x32_bf16 v[192:195], v[116:119], a[24:27], v[192:195]
    ds_read_b64_tr_b16 v[104:105], v254 offset:32768
    v_exp_f32 v211, v211
    v_exp_f32 v212, v212
    v_exp_f32 v213, v213
    v_mfma_f32_16x16x32_bf16 v[196:199], v[116:119], a[96:99], v[196:199]
    ds_read_b64_tr_b16 v[106:107], v254 offset:33792
    v_exp_f32 v214, v214
    v_exp_f32 v215, v215
    v_mfma_f32_16x16x32_bf16 v[248:251], v[228:231], v[120:123], v[248:251]
    ds_read_b64_tr_b16 v[108:109], v255 offset:32768
    v_fma_f32 v208, v208, v46, v46
    v_fma_f32 v209, v209, v46, v46
    v_fma_f32 v210, v210, v46, v46
    v_mfma_f32_16x16x32_bf16 v[200:203], v[120:123], a[24:27], v[200:203]
    ds_read_b64_tr_b16 v[110:111], v255 offset:33792
    v_fma_f32 v211, v211, v46, v46
    v_fma_f32 v212, v212, v46, v46
    v_fma_f32 v213, v213, v46, v46
    v_fma_f32 v214, v214, v46, v46
    s_add_u32 m0, m0, 4224
    s_lshl_b32 s21, s21, 10
    s_add_u32 s21, s21, s30
    s_add_u32 s21, s21, 589824
    buffer_load_dwordx4 v10, s[52:55], s21 offen sc1 lds
    v_mfma_f32_16x16x32_bf16 v[204:207], v[120:123], a[96:99], v[204:207]
    s_waitcnt lgkmcnt(6)
    v_fma_f32 v215, v215, v46, v46
    v_rcp_f32 v208, v208
    v_rcp_f32 v209, v209
    v_mfma_f32_16x16x32_bf16 v[184:187], v[124:127], a[28:31], v[184:187]
    ds_read_b64_tr_b16 v[112:113], v13 offset:8192
    v_rcp_f32 v210, v210
    v_rcp_f32 v211, v211
    v_mfma_f32_16x16x32_bf16 v[188:191], v[124:127], a[100:103], v[188:191]
    ds_read_b64_tr_b16 v[114:115], v13 offset:8448
    v_rcp_f32 v212, v212
    v_rcp_f32 v213, v213
    v_mfma_f32_16x16x32_bf16 v[192:195], v[128:131], a[28:31], v[192:195]
    ds_read_b64_tr_b16 v[116:117], v14 offset:0
    v_rcp_f32 v214, v214
    v_rcp_f32 v215, v215
    v_mul_f32 v152, v152, v208
    v_mfma_f32_16x16x32_bf16 v[196:199], v[128:131], a[100:103], v[196:199]
    s_waitcnt lgkmcnt(5)
    ds_read_b64_tr_b16 v[118:119], v14 offset:1024
    v_mul_f32 v153, v153, v209
    v_mul_f32 v154, v154, v210
    v_mul_f32 v155, v155, v211
    v_mul_f32 v160, v160, v212
    v_mfma_f32_16x16x32_bf16 v[248:251], v[228:231], v[132:135], v[248:251]
    ds_read_b64_tr_b16 v[120:121], v15 offset:0
    v_mul_f32 v161, v161, v213
    v_mul_f32 v162, v162, v214
    v_mul_f32 v163, v163, v215
    v_cvt_pk_bf16_f32 v96, v152, v153
    s_add_u32 s21, s89, 0
    s_mov_b32 s13, 37888
    s_add_u32 s12, s90, 0
    s_cmp_ge_u32 s3, 1
    s_cselect_b32 s21, s12, s21
    s_cselect_b32 s13, 47360, s13
    s_add_u32 s12, s91, 0
    s_cmp_ge_u32 s3, 2
    s_cselect_b32 s21, s12, s21
    s_cselect_b32 s13, 56832, s13
    s_mov_b32 m0, s13
    s_mul_i32 s20, s21, 36864
    s_add_u32 s20, s20, s0
    buffer_load_dwordx4 v68, s[48:51], s20 offen offset:0 lds
    v_mfma_f32_16x16x32_bf16 v[200:203], v[132:135], a[28:31], v[200:203]
    ds_read_b64_tr_b16 v[122:123], v15 offset:1024
    v_cvt_pk_bf16_f32 v97, v154, v155
    v_cvt_pk_bf16_f32 v98, v160, v161
    v_cvt_pk_bf16_f32 v99, v162, v163
    buffer_store_dwordx4 v[96:99], v10, s[52:55], s92 offen offset:1024 sc1
    v_mfma_f32_16x16x32_bf16 v[204:207], v[132:135], a[100:103], v[204:207]
    v_mul_f32 v216, v156, v156
    v_mul_f32 v217, v157, v157
    v_mul_f32 v218, v158, v158
    v_mfma_f32_16x16x32_bf16 v[184:187], v[104:107], a[32:35], v[184:187]
    ds_read_b64_tr_b16 v[124:125], v13 offset:9216
    v_mul_f32 v219, v159, v159
    v_mul_f32 v220, v164, v164
    v_mul_f32 v221, v165, v165
    v_mul_f32 v222, v166, v166
    v_mfma_f32_16x16x32_bf16 v[188:191], v[104:107], a[104:107], v[188:191]
    s_waitcnt lgkmcnt(5)
    ds_read_b64_tr_b16 v[126:127], v13 offset:9472
    v_mul_f32 v223, v167, v167
    v_fma_f32 v216, v216, v49, v48
    v_fma_f32 v217, v217, v49, v48
    v_fma_f32 v218, v218, v49, v48
    v_mfma_f32_16x16x32_bf16 v[192:195], v[108:111], a[32:35], v[192:195]
    ds_read_b64_tr_b16 v[128:129], v14 offset:4096
    v_fma_f32 v219, v219, v49, v48
    v_fma_f32 v220, v220, v49, v48
    v_fma_f32 v221, v221, v49, v48
    v_fma_f32 v222, v222, v49, v48
    v_mfma_f32_16x16x32_bf16 v[196:199], v[108:111], a[104:107], v[196:199]
    ds_read_b64_tr_b16 v[130:131], v14 offset:5120
    v_fma_f32 v223, v223, v49, v48
    v_mul_f32 v216, v156, v216
    v_mul_f32 v217, v157, v217
    v_mul_f32 v218, v158, v218
    v_mul_f32 v219, v159, v219
    buffer_load_dwordx4 v69, s[48:51], s20 offen offset:1056 lds
    v_mfma_f32_16x16x32_bf16 v[248:251], v[228:231], v[112:115], v[248:251]
    ds_read_b64_tr_b16 v[132:133], v15 offset:4096
    v_mul_f32 v220, v164, v220
    v_mul_f32 v221, v165, v221
    v_mul_f32 v222, v166, v222
    v_mul_f32 v223, v167, v223
    v_mfma_f32_16x16x32_bf16 v[200:203], v[112:115], a[32:35], v[200:203]
    ds_read_b64_tr_b16 v[134:135], v15 offset:5120
    v_exp_f32 v216, v216
    v_exp_f32 v217, v217
    v_mfma_f32_16x16x32_bf16 v[204:207], v[112:115], a[104:107], v[204:207]
    s_waitcnt lgkmcnt(6)
    v_exp_f32 v218, v218
    v_exp_f32 v219, v219
    v_exp_f32 v220, v220
    v_mfma_f32_16x16x32_bf16 v[184:187], v[116:119], a[36:39], v[184:187]
    ds_read_b64_tr_b16 v[104:105], v13 offset:10240
    v_exp_f32 v221, v221
    v_exp_f32 v222, v222
    v_mfma_f32_16x16x32_bf16 v[188:191], v[116:119], a[108:111], v[188:191]
    ds_read_b64_tr_b16 v[106:107], v13 offset:10496
    v_exp_f32 v223, v223
    v_fma_f32 v216, v216, v50, v50
    v_mfma_f32_16x16x32_bf16 v[192:195], v[120:123], a[36:39], v[192:195]
    ds_read_b64_tr_b16 v[108:109], v14 offset:8192
    v_fma_f32 v217, v217, v50, v50
    v_fma_f32 v218, v218, v50, v50
    v_fma_f32 v219, v219, v50, v50
    v_fma_f32 v220, v220, v50, v50
    buffer_load_dwordx4 v70, s[48:51], s20 offen offset:2112 lds
    s_waitcnt vmcnt(6)
    buffer_store_dwordx2 v[24:25], v19, s[52:55], s22 offen offset:0 sc1
    v_mfma_f32_16x16x32_bf16 v[196:199], v[120:123], a[108:111], v[196:199]
    s_waitcnt lgkmcnt(5)
    ds_read_b64_tr_b16 v[110:111], v14 offset:9216
    v_fma_f32 v221, v221, v50, v50
    v_fma_f32 v222, v222, v50, v50
    v_fma_f32 v223, v223, v50, v50
    v_rcp_f32 v216, v216
    v_mfma_f32_16x16x32_bf16 v[248:251], v[228:231], v[124:127], v[248:251]
    ds_read_b64_tr_b16 v[112:113], v15 offset:8192
    v_rcp_f32 v217, v217
    v_rcp_f32 v218, v218
    v_mfma_f32_16x16x32_bf16 v[200:203], v[124:127], a[36:39], v[200:203]
    ds_read_b64_tr_b16 v[114:115], v15 offset:9216
    v_rcp_f32 v219, v219
    v_rcp_f32 v220, v220
    v_mfma_f32_16x16x32_bf16 v[204:207], v[124:127], a[108:111], v[204:207]
    v_rcp_f32 v221, v221
    v_rcp_f32 v222, v222
    v_mfma_f32_16x16x32_bf16 v[184:187], v[128:131], a[40:43], v[184:187]
    ds_read_b64_tr_b16 v[116:117], v13 offset:11264
    v_rcp_f32 v223, v223
    v_mul_f32 v156, v156, v216
    v_mul_f32 v157, v157, v217
    v_mul_f32 v158, v158, v218
    v_mfma_f32_16x16x32_bf16 v[188:191], v[128:131], a[112:115], v[188:191]
    s_waitcnt lgkmcnt(5)
    ds_read_b64_tr_b16 v[118:119], v13 offset:11520
    v_mul_f32 v159, v159, v219
    v_mul_f32 v164, v164, v220
    v_mul_f32 v165, v165, v221
    v_mul_f32 v166, v166, v222
    buffer_load_dwordx4 v71, s[48:51], s20 offen offset:3168 lds
    v_mfma_f32_16x16x32_bf16 v[192:195], v[132:135], a[40:43], v[192:195]
    ds_read_b64_tr_b16 v[120:121], v14 offset:12288
    v_mul_f32 v167, v167, v223
    v_cvt_pk_bf16_f32 v100, v156, v157
    v_cvt_pk_bf16_f32 v101, v158, v159
    v_cvt_pk_bf16_f32 v102, v164, v165
    v_mfma_f32_16x16x32_bf16 v[196:199], v[132:135], a[112:115], v[196:199]
    ds_read_b64_tr_b16 v[122:123], v14 offset:13312
    v_cvt_pk_bf16_f32 v103, v166, v167
    buffer_store_dwordx4 v[100:103], v12, s[52:55], s92 offen offset:1024 sc1
    v_mfma_f32_16x16x32_bf16 v[248:251], v[228:231], v[104:107], v[248:251]
    ds_read_b64_tr_b16 v[124:125], v15 offset:12288
    v_mul_f32 v208, v168, v168
    v_mul_f32 v209, v169, v169
    v_mul_f32 v210, v170, v170
    v_mul_f32 v211, v171, v171
    v_mul_f32 v212, v176, v176
    v_mfma_f32_16x16x32_bf16 v[200:203], v[104:107], a[40:43], v[200:203]
    ds_read_b64_tr_b16 v[126:127], v15 offset:13312
    v_mul_f32 v213, v177, v177
    v_mul_f32 v214, v178, v178
    v_mul_f32 v215, v179, v179
    v_fma_f32 v208, v208, v45, v44
    v_mfma_f32_16x16x32_bf16 v[204:207], v[104:107], a[112:115], v[204:207]
    s_waitcnt lgkmcnt(6)
    v_fma_f32 v209, v209, v45, v44
    v_fma_f32 v210, v210, v45, v44
    v_fma_f32 v211, v211, v45, v44
    v_fma_f32 v212, v212, v45, v44
    v_mfma_f32_16x16x32_bf16 v[184:187], v[108:111], a[44:47], v[184:187]
    ds_read_b64_tr_b16 v[128:129], v13 offset:12288
    v_fma_f32 v213, v213, v45, v44
    v_fma_f32 v214, v214, v45, v44
    v_fma_f32 v215, v215, v45, v44
    v_mul_f32 v208, v168, v208
    s_add_u32 m0, m0, 4224
    s_add_u32 s20, s20, 4608
    buffer_load_dwordx4 v68, s[48:51], s20 offen offset:0 lds
    v_mfma_f32_16x16x32_bf16 v[188:191], v[108:111], a[116:119], v[188:191]
    ds_read_b64_tr_b16 v[130:131], v13 offset:12544
    v_mul_f32 v209, v169, v209
    v_mul_f32 v210, v170, v210
    v_mul_f32 v211, v171, v211
    v_mul_f32 v212, v176, v212
    v_mfma_f32_16x16x32_bf16 v[192:195], v[112:115], a[44:47], v[192:195]
    ds_read_b64_tr_b16 v[132:133], v14 offset:16384
    v_mul_f32 v213, v177, v213
    v_mul_f32 v214, v178, v214
    v_mul_f32 v215, v179, v215
    v_exp_f32 v208, v208
    v_mfma_f32_16x16x32_bf16 v[196:199], v[112:115], a[116:119], v[196:199]
    s_waitcnt lgkmcnt(5)
    ds_read_b64_tr_b16 v[134:135], v14 offset:17408
    v_exp_f32 v209, v209
    v_exp_f32 v210, v210
    v_mfma_f32_16x16x32_bf16 v[248:251], v[228:231], v[116:119], v[248:251]
    ds_read_b64_tr_b16 v[104:105], v15 offset:16384
    v_exp_f32 v211, v211
    v_exp_f32 v212, v212
    v_mfma_f32_16x16x32_bf16 v[200:203], v[116:119], a[44:47], v[200:203]
    ds_read_b64_tr_b16 v[106:107], v15 offset:17408
    v_exp_f32 v213, v213
    v_exp_f32 v214, v214
    v_mfma_f32_16x16x32_bf16 v[204:207], v[116:119], a[116:119], v[204:207]
    v_exp_f32 v215, v215
    v_fma_f32 v208, v208, v46, v46
    v_fma_f32 v209, v209, v46, v46
    buffer_load_dwordx4 v69, s[48:51], s20 offen offset:1056 lds
    v_mfma_f32_16x16x32_bf16 v[184:187], v[120:123], a[48:51], v[184:187]
    ds_read_b64_tr_b16 v[108:109], v13 offset:13312
    v_fma_f32 v210, v210, v46, v46
    v_fma_f32 v211, v211, v46, v46
    v_fma_f32 v212, v212, v46, v46
    v_fma_f32 v213, v213, v46, v46
    v_mfma_f32_16x16x32_bf16 v[188:191], v[120:123], a[120:123], v[188:191]
    s_waitcnt lgkmcnt(5)
    ds_read_b64_tr_b16 v[110:111], v13 offset:13568
    v_fma_f32 v214, v214, v46, v46
    v_fma_f32 v215, v215, v46, v46
    v_rcp_f32 v208, v208
    v_mfma_f32_16x16x32_bf16 v[192:195], v[124:127], a[48:51], v[192:195]
    ds_read_b64_tr_b16 v[112:113], v14 offset:20480
    v_rcp_f32 v209, v209
    v_rcp_f32 v210, v210
    v_rcp_f32 v211, v211
    v_mfma_f32_16x16x32_bf16 v[196:199], v[124:127], a[120:123], v[196:199]
    ds_read_b64_tr_b16 v[114:115], v14 offset:21504
    v_rcp_f32 v212, v212
    v_rcp_f32 v213, v213
    v_mfma_f32_16x16x32_bf16 v[248:251], v[228:231], v[128:131], v[248:251]
    ds_read_b64_tr_b16 v[116:117], v15 offset:20480
    v_rcp_f32 v214, v214
    v_rcp_f32 v215, v215
    v_mfma_f32_16x16x32_bf16 v[200:203], v[128:131], a[48:51], v[200:203]
    ds_read_b64_tr_b16 v[118:119], v15 offset:21504
    v_mul_f32 v168, v168, v208
    v_mul_f32 v169, v169, v209
    v_mul_f32 v170, v170, v210
    buffer_load_dwordx4 v70, s[48:51], s20 offen offset:2112 lds
    v_mfma_f32_16x16x32_bf16 v[204:207], v[128:131], a[120:123], v[204:207]
    s_waitcnt lgkmcnt(6)
    v_mul_f32 v171, v171, v211
    v_mul_f32 v176, v176, v212
    v_mul_f32 v177, v177, v213
    v_mul_f32 v178, v178, v214
    v_mfma_f32_16x16x32_bf16 v[184:187], v[132:135], a[52:55], v[184:187]
    ds_read_b64_tr_b16 v[120:121], v13 offset:14336
    v_mul_f32 v179, v179, v215
    v_cvt_pk_bf16_f32 v232, v168, v169
    v_cvt_pk_bf16_f32 v233, v170, v171
    v_cvt_pk_bf16_f32 v234, v176, v177
    v_mfma_f32_16x16x32_bf16 v[188:191], v[132:135], a[124:127], v[188:191]
    ds_read_b64_tr_b16 v[122:123], v13 offset:14592
    v_cvt_pk_bf16_f32 v235, v178, v179
    buffer_store_dwordx4 v[232:235], v10, s[52:55], s92 offen offset:2048 sc1
    v_mfma_f32_16x16x32_bf16 v[192:195], v[104:107], a[52:55], v[192:195]
    ds_read_b64_tr_b16 v[124:125], v14 offset:24576
    v_mul_f32 v216, v172, v172
    v_mul_f32 v217, v173, v173
    v_mul_f32 v218, v174, v174
    v_mul_f32 v219, v175, v175
    v_mul_f32 v220, v180, v180
    v_mfma_f32_16x16x32_bf16 v[196:199], v[104:107], a[124:127], v[196:199]
    s_waitcnt lgkmcnt(5)
    ds_read_b64_tr_b16 v[126:127], v14 offset:25600
    v_mul_f32 v221, v181, v181
    v_mul_f32 v222, v182, v182
    v_mul_f32 v223, v183, v183
    v_fma_f32 v216, v216, v49, v48
    v_mfma_f32_16x16x32_bf16 v[248:251], v[228:231], v[108:111], v[248:251]
    ds_read_b64_tr_b16 v[128:129], v15 offset:24576
    v_fma_f32 v217, v217, v49, v48
    v_fma_f32 v218, v218, v49, v48
    v_fma_f32 v219, v219, v49, v48
    v_fma_f32 v220, v220, v49, v48
    buffer_load_dwordx4 v71, s[48:51], s20 offen offset:3168 lds
    v_mfma_f32_16x16x32_bf16 v[200:203], v[108:111], a[52:55], v[200:203]
    ds_read_b64_tr_b16 v[130:131], v15 offset:25600
    v_fma_f32 v221, v221, v49, v48
    v_fma_f32 v222, v222, v49, v48
    v_fma_f32 v223, v223, v49, v48
    v_mul_f32 v216, v172, v216
    v_mfma_f32_16x16x32_bf16 v[204:207], v[108:111], a[124:127], v[204:207]
    v_mul_f32 v217, v173, v217
    v_mul_f32 v218, v174, v218
    v_mul_f32 v219, v175, v219
    v_mul_f32 v220, v180, v220
    v_mfma_f32_16x16x32_bf16 v[184:187], v[112:115], a[56:59], v[184:187]
    ds_read_b64_tr_b16 v[132:133], v13 offset:15360
    v_mul_f32 v221, v181, v221
    v_mul_f32 v222, v182, v222
    v_mul_f32 v223, v183, v223
    v_exp_f32 v216, v216
    buffer_load_dwordx2 v[20:21], v22, s[52:55], 0 offen offset:0 sc1
    v_mfma_f32_16x16x32_bf16 v[188:191], v[112:115], a[128:131], v[188:191]
    s_waitcnt lgkmcnt(5)
    ds_read_b64_tr_b16 v[134:135], v13 offset:15616
    v_exp_f32 v217, v217
    v_exp_f32 v218, v218
    v_mfma_f32_16x16x32_bf16 v[192:195], v[116:119], a[56:59], v[192:195]
    ds_read_b64_tr_b16 v[104:105], v14 offset:28672
    v_exp_f32 v219, v219
    v_exp_f32 v220, v220
    v_mfma_f32_16x16x32_bf16 v[196:199], v[116:119], a[128:131], v[196:199]
    ds_read_b64_tr_b16 v[106:107], v14 offset:29696
    v_exp_f32 v221, v221
    v_exp_f32 v222, v222
    s_add_u32 m0, m0, 4224
    s_lshl_b32 s21, s21, 10
    s_add_u32 s21, s21, s30
    s_add_u32 s21, s21, 589824
    buffer_load_dwordx4 v10, s[52:55], s21 offen sc1 lds
    v_mfma_f32_16x16x32_bf16 v[248:251], v[228:231], v[120:123], v[248:251]
    ds_read_b64_tr_b16 v[108:109], v15 offset:28672
    v_exp_f32 v223, v223
    v_fma_f32 v216, v216, v50, v50
    v_fma_f32 v217, v217, v50, v50
    s_waitcnt vmcnt(7)
    buffer_store_dwordx2 v[24:25], v19, s[52:55], s22 offen offset:128 sc1
    v_mfma_f32_16x16x32_bf16 v[200:203], v[120:123], a[56:59], v[200:203]
    ds_read_b64_tr_b16 v[110:111], v15 offset:29696
    v_fma_f32 v218, v218, v50, v50
    v_fma_f32 v219, v219, v50, v50
    v_fma_f32 v220, v220, v50, v50
    v_fma_f32 v221, v221, v50, v50
    v_mfma_f32_16x16x32_bf16 v[204:207], v[120:123], a[128:131], v[204:207]
    s_waitcnt lgkmcnt(6)
    v_fma_f32 v222, v222, v50, v50
    v_fma_f32 v223, v223, v50, v50
    v_rcp_f32 v216, v216
    v_mfma_f32_16x16x32_bf16 v[184:187], v[124:127], a[60:63], v[184:187]
    v_rcp_f32 v217, v217
    v_rcp_f32 v218, v218
    v_rcp_f32 v219, v219
    v_mfma_f32_16x16x32_bf16 v[188:191], v[124:127], a[132:135], v[188:191]
    v_rcp_f32 v220, v220
    v_rcp_f32 v221, v221
    v_mfma_f32_16x16x32_bf16 v[192:195], v[128:131], a[60:63], v[192:195]
    ds_read_b64_tr_b16 v[112:113], v14 offset:32768
    v_rcp_f32 v222, v222
    v_rcp_f32 v223, v223
    v_mfma_f32_16x16x32_bf16 v[196:199], v[128:131], a[132:135], v[196:199]
    s_waitcnt lgkmcnt(3)
    ds_read_b64_tr_b16 v[114:115], v14 offset:33792
    v_mul_f32 v172, v172, v216
    v_mul_f32 v173, v173, v217
    v_mul_f32 v174, v174, v218
    v_mfma_f32_16x16x32_bf16 v[248:251], v[228:231], v[132:135], v[248:251]
    ds_read_b64_tr_b16 v[116:117], v15 offset:32768
    v_mul_f32 v175, v175, v219
    v_mul_f32 v180, v180, v220
    v_mul_f32 v181, v181, v221
    v_mul_f32 v182, v182, v222
    v_mfma_f32_16x16x32_bf16 v[200:203], v[132:135], a[60:63], v[200:203]
    ds_read_b64_tr_b16 v[118:119], v15 offset:33792
    v_mul_f32 v183, v183, v223
    v_cvt_pk_bf16_f32 v236, v172, v173
    v_cvt_pk_bf16_f32 v237, v174, v175
    v_cvt_pk_bf16_f32 v238, v180, v181
    v_mfma_f32_16x16x32_bf16 v[204:207], v[132:135], a[132:135], v[204:207]
    v_cvt_pk_bf16_f32 v239, v182, v183
    buffer_store_dwordx4 v[236:239], v12, s[52:55], s92 offen offset:2048 sc1
    v_mfma_f32_16x16x32_bf16 v[184:187], v[104:107], a[64:67], v[184:187]
    v_mfma_f32_16x16x32_bf16 v[188:191], v[104:107], a[136:139], v[188:191]
    s_waitcnt lgkmcnt(4)
    v_mfma_f32_16x16x32_bf16 v[192:195], v[108:111], a[64:67], v[192:195]
    v_mfma_f32_16x16x32_bf16 v[196:199], v[108:111], a[136:139], v[196:199]
    v_mfma_f32_16x16x32_bf16 v[248:251], v[228:231], a[192:195], v[248:251]
    v_mfma_f32_16x16x32_bf16 v[200:203], a[192:195], a[64:67], v[200:203]
    v_mfma_f32_16x16x32_bf16 v[204:207], a[192:195], a[136:139], v[204:207]
    s_waitcnt lgkmcnt(0)
    v_mfma_f32_16x16x32_bf16 v[184:187], v[112:115], a[68:71], v[184:187]
    v_mfma_f32_16x16x32_bf16 v[188:191], v[112:115], a[140:143], v[188:191]
    v_mfma_f32_16x16x32_bf16 v[192:195], v[116:119], a[68:71], v[192:195]
    v_mfma_f32_16x16x32_bf16 v[196:199], v[116:119], a[140:143], v[196:199]
    v_mfma_f32_16x16x32_bf16 v[248:251], v[228:231], a[196:199], v[248:251]
    v_mfma_f32_16x16x32_bf16 v[200:203], a[196:199], a[68:71], v[200:203]
    v_mfma_f32_16x16x32_bf16 v[204:207], a[196:199], a[140:143], v[204:207]
    v_accvgpr_read_b32 v60, a236
    v_accvgpr_read_b32 v61, a237
    v_accvgpr_read_b32 v64, a238
    v_accvgpr_read_b32 v65, a239
    v_mfma_f32_16x16x32_bf16 v[184:187], v[60:63], v[52:55], v[184:187]
    v_mfma_f32_16x16x32_bf16 v[188:191], v[60:63], v[56:59], v[188:191]
    v_mfma_f32_16x16x32_bf16 v[192:195], v[64:67], v[52:55], v[192:195]
    v_mfma_f32_16x16x32_bf16 v[196:199], v[64:67], v[56:59], v[196:199]
    v_and_b32 v249, 0xffff0000, v248
    v_sub_f32 v248, v248, v249
    v_and_b32 v250, 0xffff0000, v248
    v_sub_f32 v248, v248, v250
    v_cvt_pk_bf16_f32 v32, v249, v250
    v_cvt_pk_bf16_f32 v33, v248, 0

    v_mov_b32 v60, v32
    v_mov_b32 v61, v33
    s_nop 1
    v_mfma_f32_16x16x32_bf16 v[200:203], v[60:63], v[52:55], v[200:203]
    v_mfma_f32_16x16x32_bf16 v[204:207], v[60:63], v[56:59], v[204:207]
    s_waitcnt vmcnt(2)
    s_barrier
    ds_read_b64_tr_b16 v[120:121], v72 offset:8448
    ds_read_b64_tr_b16 v[122:123], v72 offset:8704
    ds_read_b64_tr_b16 v[124:125], v26 offset:0
    ds_read_b64_tr_b16 v[126:127], v26 offset:256
    ds_read_b64_tr_b16 v[128:129], v26 offset:32
    ds_read_b64_tr_b16 v[130:131], v26 offset:288
    ds_read_b64_tr_b16 v[132:133], v26 offset:64
    ds_read_b64_tr_b16 v[134:135], v26 offset:320
    ds_read_b64_tr_b16 v[104:105], v26 offset:96
    ds_read_b64_tr_b16 v[106:107], v26 offset:352
    s_waitcnt lgkmcnt(8)
    v_mfma_f32_16x16x32_bf16 a[48:51], v[120:123], v[88:91], 0
    ds_read_b64_tr_b16 v[108:109], v26 offset:128
    v_mfma_f32_16x16x32_bf16 a[52:55], v[120:123], v[92:95], 0
    s_waitcnt lgkmcnt(5)
    ds_read_b64_tr_b16 v[110:111], v26 offset:384
    v_mfma_f32_16x16x32_bf16 a[56:59], v[124:127], v[88:91], 0
    ds_read_b64_tr_b16 v[112:113], v26 offset:160
    v_mul_f32 v208, v184, v184
    v_mul_f32 v209, v185, v185
    v_mul_f32 v210, v186, v186
    v_mul_f32 v211, v187, v187
    v_mul_f32 v212, v192, v192
    v_mul_f32 v213, v193, v193
    v_mul_f32 v214, v194, v194
    v_mfma_f32_16x16x32_bf16 a[60:63], v[124:127], v[92:95], 0
    ds_read_b64_tr_b16 v[114:115], v26 offset:416
    v_mul_f32 v215, v195, v195
    v_fma_f32 v208, v208, v45, v44
    v_fma_f32 v209, v209, v45, v44
    v_fma_f32 v210, v210, v45, v44
    v_fma_f32 v211, v211, v45, v44
    v_fma_f32 v212, v212, v45, v44
    v_fma_f32 v213, v213, v45, v44
    v_mfma_f32_16x16x32_bf16 a[64:67], v[128:131], v[88:91], 0
    ds_read_b64_tr_b16 v[116:117], v26 offset:192
    v_fma_f32 v214, v214, v45, v44
    v_fma_f32 v215, v215, v45, v44
    v_mul_f32 v208, v184, v208
    v_mul_f32 v209, v185, v209
    v_mul_f32 v210, v186, v210
    v_mul_f32 v211, v187, v211
    s_waitcnt vmcnt(0)
    buffer_store_dwordx2 v[24:25], v19, s[52:55], s22 offen offset:256 sc1
    v_mfma_f32_16x16x32_bf16 a[68:71], v[128:131], v[92:95], 0
    s_waitcnt lgkmcnt(5)
    ds_read_b64_tr_b16 v[118:119], v26 offset:448
    v_mul_f32 v212, v192, v212
    v_mul_f32 v213, v193, v213
    v_mul_f32 v214, v194, v214
    v_mul_f32 v215, v195, v215
    v_exp_f32 v208, v208
    v_exp_f32 v209, v209
    v_mfma_f32_16x16x32_bf16 a[72:75], v[132:135], v[88:91], 0
    ds_read_b64_tr_b16 v[120:121], v26 offset:224
    v_exp_f32 v210, v210
    v_exp_f32 v211, v211
    v_exp_f32 v212, v212
    v_mfma_f32_16x16x32_bf16 a[76:79], v[132:135], v[92:95], 0
    ds_read_b64_tr_b16 v[122:123], v26 offset:480
    v_exp_f32 v213, v213
    v_exp_f32 v214, v214
    v_exp_f32 v215, v215
    v_mfma_f32_16x16x32_bf16 a[80:83], v[104:107], v[88:91], 0
    ds_read_b64_tr_b16 v[124:125], v72 offset:17920
    v_fma_f32 v208, v208, v46, v46
    v_fma_f32 v209, v209, v46, v46
    v_fma_f32 v210, v210, v46, v46
    v_fma_f32 v211, v211, v46, v46
    v_fma_f32 v212, v212, v46, v46
    v_fma_f32 v213, v213, v46, v46
    v_fma_f32 v214, v214, v46, v46
    v_mfma_f32_16x16x32_bf16 a[84:87], v[104:107], v[92:95], 0
    s_waitcnt lgkmcnt(5)
    ds_read_b64_tr_b16 v[126:127], v72 offset:18176
    v_fma_f32 v215, v215, v46, v46
    v_rcp_f32 v208, v208
    v_rcp_f32 v209, v209
    v_rcp_f32 v210, v210
    v_mfma_f32_16x16x32_bf16 a[88:91], v[108:111], v[88:91], 0
    ds_read_b64_tr_b16 v[128:129], v26 offset:9472
    v_rcp_f32 v211, v211
    v_rcp_f32 v212, v212
    v_rcp_f32 v213, v213
    v_cmp_ne_u64 vcc, v[20:21], v[24:25]
    s_and_b32 s12, vcc_lo, 0xf
    s_cbranch_scc0 poll_6_ok
    s_mov_b32 s14, 0
poll_6:
    s_sleep 3
    buffer_load_dwordx2 v[20:21], v22, s[52:55], 0 offen offset:0 sc1
    s_add_u32 s14, s14, 1
    s_cmp_gt_u32 s14, 0x8000
    s_cbranch_scc1 poll_6_ok
    s_waitcnt vmcnt(0)
    v_cmp_ne_u64 vcc, v[20:21], v[24:25]
    s_and_b32 s12, vcc_lo, 0xf
    s_cbranch_scc1 poll_6
poll_6_ok:

    v_mfma_f32_16x16x32_bf16 a[92:95], v[108:111], v[92:95], 0
    ds_read_b64_tr_b16 v[130:131], v26 offset:9728
    v_rcp_f32 v214, v214
    v_rcp_f32 v215, v215
    v_mul_f32 v184, v184, v208
    v_mul_f32 v185, v185, v209
    buffer_load_dwordx4 a[144:147], v10, s[52:55], s93 offen offset:0 sc1
    buffer_load_dwordx4 a[148:151], v12, s[52:55], s93 offen offset:0 sc1
    v_mfma_f32_16x16x32_bf16 a[96:99], v[112:115], v[88:91], 0
    ds_read_b64_tr_b16 v[132:133], v26 offset:9504
    v_mul_f32 v186, v186, v210
    v_mul_f32 v187, v187, v211
    v_mul_f32 v192, v192, v212
    v_mul_f32 v193, v193, v213
    v_mul_f32 v194, v194, v214
    v_mul_f32 v195, v195, v215
    v_cvt_pk_bf16_f32 v240, v184, v185
    buffer_load_dwordx4 a[152:155], v10, s[52:55], s94 offen offset:0 sc1
    buffer_load_dwordx4 a[156:159], v12, s[52:55], s94 offen offset:0 sc1
    v_mfma_f32_16x16x32_bf16 a[100:103], v[112:115], v[92:95], 0
    s_waitcnt lgkmcnt(5)
    ds_read_b64_tr_b16 v[134:135], v26 offset:9760
    v_cvt_pk_bf16_f32 v241, v186, v187
    v_cvt_pk_bf16_f32 v242, v192, v193
    v_cvt_pk_bf16_f32 v243, v194, v195
    buffer_store_dwordx4 v[240:243], v10, s[52:55], s92 offen offset:3072 sc1
    buffer_load_dwordx4 a[160:163], v10, s[52:55], s95 offen offset:0 sc1
    buffer_load_dwordx4 a[164:167], v12, s[52:55], s95 offen offset:0 sc1
    v_mfma_f32_16x16x32_bf16 a[104:107], v[116:119], v[88:91], 0
    ds_read_b64_tr_b16 v[104:105], v26 offset:9536
    v_mul_f32 v216, v188, v188
    v_mul_f32 v217, v189, v189
    v_mul_f32 v218, v190, v190
    v_mul_f32 v219, v191, v191
    v_mul_f32 v220, v196, v196
    v_mul_f32 v221, v197, v197
    v_mul_f32 v222, v198, v198
    buffer_load_dwordx2 v[20:21], v22, s[52:55], 0 offen offset:128 sc1
    v_mfma_f32_16x16x32_bf16 a[108:111], v[116:119], v[92:95], 0
    ds_read_b64_tr_b16 v[106:107], v26 offset:9792
    v_mul_f32 v223, v199, v199
    v_fma_f32 v216, v216, v49, v48
    v_fma_f32 v217, v217, v49, v48
    v_fma_f32 v218, v218, v49, v48
    v_fma_f32 v219, v219, v49, v48
    v_fma_f32 v220, v220, v49, v48
    v_fma_f32 v221, v221, v49, v48
    v_mfma_f32_16x16x32_bf16 a[112:115], v[120:123], v[88:91], 0
    ds_read_b64_tr_b16 v[108:109], v26 offset:9568
    v_fma_f32 v222, v222, v49, v48
    v_fma_f32 v223, v223, v49, v48
    v_mul_f32 v216, v188, v216
    v_mul_f32 v217, v189, v217
    v_mul_f32 v218, v190, v218
    v_mul_f32 v219, v191, v219
    v_mfma_f32_16x16x32_bf16 a[116:119], v[120:123], v[92:95], 0
    s_waitcnt lgkmcnt(5)
    ds_read_b64_tr_b16 v[110:111], v26 offset:9824
    v_mul_f32 v220, v196, v220
    v_mul_f32 v221, v197, v221
    v_mul_f32 v222, v198, v222
    v_mul_f32 v223, v199, v223
    v_exp_f32 v216, v216
    v_exp_f32 v217, v217
    v_mfma_f32_16x16x32_bf16 a[48:51], v[124:127], v[96:99], a[48:51]
    ds_read_b64_tr_b16 v[112:113], v26 offset:9600
    v_exp_f32 v218, v218
    v_exp_f32 v219, v219
    v_exp_f32 v220, v220
    s_add_u32 s21, s89, 1
    s_mov_b32 s13, 66304
    s_add_u32 s12, s90, 1
    s_cmp_ge_u32 s3, 1
    s_cselect_b32 s21, s12, s21
    s_cselect_b32 s13, 75776, s13
    s_add_u32 s12, s91, 1
    s_cmp_ge_u32 s3, 2
    s_cselect_b32 s21, s12, s21
    s_cselect_b32 s13, 85248, s13
    s_add_u32 s12, s89, 2
    s_cmp_ge_u32 s3, 3
    s_cselect_b32 s21, s12, s21
    s_cselect_b32 s13, 94720, s13
    s_mov_b32 m0, s13
    s_mul_i32 s20, s21, 36864
    s_add_u32 s20, s20, s0
    buffer_load_dwordx4 v68, s[48:51], s20 offen offset:0 lds
    v_mfma_f32_16x16x32_bf16 a[52:55], v[124:127], v[100:103], a[52:55]
    ds_read_b64_tr_b16 v[114:115], v26 offset:9856
    v_exp_f32 v221, v221
    v_exp_f32 v222, v222
    v_exp_f32 v223, v223
    v_mfma_f32_16x16x32_bf16 a[56:59], v[128:131], v[96:99], a[56:59]
    ds_read_b64_tr_b16 v[116:117], v26 offset:9632
    v_fma_f32 v216, v216, v50, v50
    v_fma_f32 v217, v217, v50, v50
    v_fma_f32 v218, v218, v50, v50
    v_fma_f32 v219, v219, v50, v50
    v_fma_f32 v220, v220, v50, v50
    v_fma_f32 v221, v221, v50, v50
    v_fma_f32 v222, v222, v50, v50
    v_mfma_f32_16x16x32_bf16 a[60:63], v[128:131], v[100:103], a[60:63]
    s_waitcnt lgkmcnt(5)
    ds_read_b64_tr_b16 v[118:119], v26 offset:9888
    v_fma_f32 v223, v223, v50, v50
    v_rcp_f32 v216, v216
    v_rcp_f32 v217, v217
    v_rcp_f32 v218, v218
    v_mfma_f32_16x16x32_bf16 a[64:67], v[132:135], v[96:99], a[64:67]
    ds_read_b64_tr_b16 v[120:121], v26 offset:9664
    v_rcp_f32 v219, v219
    v_rcp_f32 v220, v220
    v_rcp_f32 v221, v221
    buffer_load_dwordx4 v69, s[48:51], s20 offen offset:1056 lds
    v_mfma_f32_16x16x32_bf16 a[68:71], v[132:135], v[100:103], a[68:71]
    ds_read_b64_tr_b16 v[122:123], v26 offset:9920
    v_rcp_f32 v222, v222
    v_rcp_f32 v223, v223
    v_mul_f32 v188, v188, v216
    v_mul_f32 v189, v189, v217
    v_mfma_f32_16x16x32_bf16 a[72:75], v[104:107], v[96:99], a[72:75]
    ds_read_b64_tr_b16 v[124:125], v72 offset:27392
    v_mul_f32 v190, v190, v218
    v_mul_f32 v191, v191, v219
    v_mul_f32 v196, v196, v220
    v_mul_f32 v197, v197, v221
    v_mul_f32 v198, v198, v222
    v_mul_f32 v199, v199, v223
    v_cvt_pk_bf16_f32 v244, v188, v189
    v_mfma_f32_16x16x32_bf16 a[76:79], v[104:107], v[100:103], a[76:79]
    s_waitcnt lgkmcnt(5)
    ds_read_b64_tr_b16 v[126:127], v72 offset:27648
    v_cvt_pk_bf16_f32 v245, v190, v191
    v_cvt_pk_bf16_f32 v246, v196, v197
    v_cvt_pk_bf16_f32 v247, v198, v199
    buffer_store_dwordx4 v[244:247], v12, s[52:55], s92 offen offset:3072 sc1
    v_mfma_f32_16x16x32_bf16 a[80:83], v[108:111], v[96:99], a[80:83]
    ds_read_b64_tr_b16 v[128:129], v26 offset:18944
    v_mul_f32 v208, v200, v200
    v_mul_f32 v209, v201, v201
    v_mul_f32 v210, v202, v202
    v_mul_f32 v211, v203, v203
    v_mul_f32 v212, v204, v204
    v_mul_f32 v213, v205, v205
    v_mul_f32 v214, v206, v206
    buffer_load_dwordx4 v70, s[48:51], s20 offen offset:2112 lds
    v_mfma_f32_16x16x32_bf16 a[84:87], v[108:111], v[100:103], a[84:87]
    ds_read_b64_tr_b16 v[130:131], v26 offset:19200
    v_mul_f32 v215, v207, v207
    v_fma_f32 v208, v208, v45, v44
    v_fma_f32 v209, v209, v45, v44
    v_fma_f32 v210, v210, v45, v44
    v_fma_f32 v211, v211, v45, v44
    v_fma_f32 v212, v212, v49, v48
    v_fma_f32 v213, v213, v49, v48
    v_mfma_f32_16x16x32_bf16 a[88:91], v[112:115], v[96:99], a[88:91]
    ds_read_b64_tr_b16 v[132:133], v26 offset:18976
    v_fma_f32 v214, v214, v49, v48
    v_fma_f32 v215, v215, v49, v48
    v_mul_f32 v208, v200, v208
    v_mul_f32 v209, v201, v209
    v_mul_f32 v210, v202, v210
    v_mul_f32 v211, v203, v211
    v_mfma_f32_16x16x32_bf16 a[92:95], v[112:115], v[100:103], a[92:95]
    s_waitcnt lgkmcnt(5)
    ds_read_b64_tr_b16 v[134:135], v26 offset:19232
    v_mul_f32 v212, v204, v212
    v_mul_f32 v213, v205, v213
    v_mul_f32 v214, v206, v214
    v_mul_f32 v215, v207, v215
    v_exp_f32 v208, v208
    v_exp_f32 v209, v209
    v_mfma_f32_16x16x32_bf16 a[96:99], v[116:119], v[96:99], a[96:99]
    ds_read_b64_tr_b16 v[104:105], v26 offset:19008
    v_exp_f32 v210, v210
    v_exp_f32 v211, v211
    v_exp_f32 v212, v212
    v_mfma_f32_16x16x32_bf16 a[100:103], v[116:119], v[100:103], a[100:103]
    ds_read_b64_tr_b16 v[106:107], v26 offset:19264
    v_exp_f32 v213, v213
    v_exp_f32 v214, v214
    v_exp_f32 v215, v215
    buffer_load_dwordx4 v71, s[48:51], s20 offen offset:3168 lds
    v_mfma_f32_16x16x32_bf16 a[104:107], v[120:123], v[96:99], a[104:107]
    ds_read_b64_tr_b16 v[108:109], v26 offset:19040
    v_fma_f32 v208, v208, v46, v46
    v_fma_f32 v209, v209, v46, v46
    v_fma_f32 v210, v210, v46, v46
    v_fma_f32 v211, v211, v46, v46
    v_fma_f32 v212, v212, v50, v50
    v_fma_f32 v213, v213, v50, v50
    v_fma_f32 v214, v214, v50, v50
    v_mfma_f32_16x16x32_bf16 a[108:111], v[120:123], v[100:103], a[108:111]
    s_waitcnt lgkmcnt(5)
    ds_read_b64_tr_b16 v[110:111], v26 offset:19296
    v_fma_f32 v215, v215, v50, v50
    v_rcp_f32 v208, v208
    v_rcp_f32 v209, v209
    v_rcp_f32 v210, v210
    v_mfma_f32_16x16x32_bf16 a[48:51], v[124:127], v[232:235], a[48:51]
    ds_read_b64_tr_b16 v[112:113], v26 offset:19072
    v_rcp_f32 v211, v211
    v_rcp_f32 v212, v212
    v_rcp_f32 v213, v213
    v_mfma_f32_16x16x32_bf16 a[52:55], v[124:127], v[236:239], a[52:55]
    ds_read_b64_tr_b16 v[114:115], v26 offset:19328
    v_rcp_f32 v214, v214
    v_rcp_f32 v215, v215
    v_mul_f32 v200, v200, v208
    v_mul_f32 v201, v201, v209
    s_add_u32 m0, m0, 4224
    s_add_u32 s20, s20, 4608
    buffer_load_dwordx4 v68, s[48:51], s20 offen offset:0 lds
    v_mfma_f32_16x16x32_bf16 a[56:59], v[128:131], v[232:235], a[56:59]
    ds_read_b64_tr_b16 v[116:117], v26 offset:19104
    v_mul_f32 v202, v202, v210
    v_mul_f32 v203, v203, v211
    v_mul_f32 v204, v204, v212
    v_mul_f32 v205, v205, v213
    v_mul_f32 v206, v206, v214
    v_mul_f32 v207, v207, v215
    v_cvt_pk_bf16_f32 v224, v200, v201
    v_mfma_f32_16x16x32_bf16 a[60:63], v[128:131], v[236:239], a[60:63]
    s_waitcnt lgkmcnt(5)
    ds_read_b64_tr_b16 v[118:119], v26 offset:19360
    v_cvt_pk_bf16_f32 v225, v202, v203
    v_cvt_pk_bf16_f32 v226, v204, v205
    v_cvt_pk_bf16_f32 v227, v206, v207
    s_lshl_b32 s12, s8, 9
    s_add_u32 s12, s12, s1
    s_add_u32 s12, s12, 16384
    s_add_u32 s13, s12, 147456
    buffer_store_dwordx2 v[224:225], v23, s[52:55], s12 offen sc1
    buffer_store_dwordx2 v[226:227], v23, s[52:55], s13 offen sc1
    v_mfma_f32_16x16x32_bf16 a[64:67], v[132:135], v[232:235], a[64:67]
    ds_read_b64_tr_b16 v[120:121], v26 offset:19136
    v_mfma_f32_16x16x32_bf16 a[68:71], v[132:135], v[236:239], a[68:71]
    ds_read_b64_tr_b16 v[122:123], v26 offset:19392
    v_mfma_f32_16x16x32_bf16 a[72:75], v[104:107], v[232:235], a[72:75]
    ds_read_b64_tr_b16 v[124:125], v72 offset:36864
    buffer_load_dwordx4 v69, s[48:51], s20 offen offset:1056 lds
    v_mfma_f32_16x16x32_bf16 a[76:79], v[104:107], v[236:239], a[76:79]
    s_waitcnt lgkmcnt(5)
    ds_read_b64_tr_b16 v[126:127], v72 offset:37120
    v_mfma_f32_16x16x32_bf16 a[80:83], v[108:111], v[232:235], a[80:83]
    ds_read_b64_tr_b16 v[128:129], v26 offset:28416
    v_mfma_f32_16x16x32_bf16 a[84:87], v[108:111], v[236:239], a[84:87]
    ds_read_b64_tr_b16 v[130:131], v26 offset:28672
    v_mfma_f32_16x16x32_bf16 a[88:91], v[112:115], v[232:235], a[88:91]
    ds_read_b64_tr_b16 v[132:133], v26 offset:28448
    buffer_load_dwordx4 v70, s[48:51], s20 offen offset:2112 lds
    v_mfma_f32_16x16x32_bf16 a[92:95], v[112:115], v[236:239], a[92:95]
    s_waitcnt lgkmcnt(5)
    ds_read_b64_tr_b16 v[134:135], v26 offset:28704
    v_mfma_f32_16x16x32_bf16 a[96:99], v[116:119], v[232:235], a[96:99]
    ds_read_b64_tr_b16 v[104:105], v26 offset:28480
    s_waitcnt vmcnt(10)
    v_cmp_ne_u64 vcc, v[20:21], v[24:25]
    s_and_b32 s12, vcc_lo, 0xf
    s_cbranch_scc0 poll_7_ok
    s_mov_b32 s14, 0
poll_7:
    s_sleep 3
    buffer_load_dwordx2 v[20:21], v22, s[52:55], 0 offen offset:128 sc1
    s_add_u32 s14, s14, 1
    s_cmp_gt_u32 s14, 0x8000
    s_cbranch_scc1 poll_7_ok
    s_waitcnt vmcnt(0)
    v_cmp_ne_u64 vcc, v[20:21], v[24:25]
    s_and_b32 s12, vcc_lo, 0xf
    s_cbranch_scc1 poll_7
poll_7_ok:

    v_mfma_f32_16x16x32_bf16 a[100:103], v[116:119], v[236:239], a[100:103]
    ds_read_b64_tr_b16 v[106:107], v26 offset:28736
    buffer_load_dwordx4 a[168:171], v10, s[52:55], s93 offen offset:1024 sc1
    buffer_load_dwordx4 a[172:175], v12, s[52:55], s93 offen offset:1024 sc1
    v_mfma_f32_16x16x32_bf16 a[104:107], v[120:123], v[232:235], a[104:107]
    ds_read_b64_tr_b16 v[108:109], v26 offset:28512
    buffer_load_dwordx4 a[176:179], v10, s[52:55], s94 offen offset:1024 sc1
    buffer_load_dwordx4 a[180:183], v12, s[52:55], s94 offen offset:1024 sc1
    v_mfma_f32_16x16x32_bf16 a[108:111], v[120:123], v[236:239], a[108:111]
    s_waitcnt lgkmcnt(5)
    ds_read_b64_tr_b16 v[110:111], v26 offset:28768
    buffer_load_dwordx4 v71, s[48:51], s20 offen offset:3168 lds
    buffer_load_dwordx4 a[184:187], v10, s[52:55], s95 offen offset:1024 sc1
    buffer_load_dwordx4 a[188:191], v12, s[52:55], s95 offen offset:1024 sc1
    v_mfma_f32_16x16x32_bf16 a[48:51], v[124:127], v[240:243], a[48:51]
    ds_read_b64_tr_b16 v[112:113], v26 offset:28544
    buffer_load_dwordx2 v[20:21], v22, s[52:55], 0 offen offset:256 sc1
    v_mfma_f32_16x16x32_bf16 a[52:55], v[124:127], v[244:247], a[52:55]
    ds_read_b64_tr_b16 v[114:115], v26 offset:28800
    v_mfma_f32_16x16x32_bf16 a[56:59], v[128:131], v[240:243], a[56:59]
    ds_read_b64_tr_b16 v[116:117], v26 offset:28576
    v_mfma_f32_16x16x32_bf16 a[60:63], v[128:131], v[244:247], a[60:63]
    s_waitcnt lgkmcnt(5)
    ds_read_b64_tr_b16 v[118:119], v26 offset:28832
    s_add_u32 m0, m0, 4224
    s_lshl_b32 s21, s21, 10
    s_add_u32 s21, s21, s30
    s_add_u32 s21, s21, 589824
    buffer_load_dwordx4 v10, s[52:55], s21 offen sc1 lds
    v_mfma_f32_16x16x32_bf16 a[64:67], v[132:135], v[240:243], a[64:67]
    ds_read_b64_tr_b16 v[120:121], v26 offset:28608
    s_waitcnt vmcnt(16)
    buffer_store_dwordx2 v[24:25], v19, s[52:55], s22 offen offset:384 sc1
    v_mfma_f32_16x16x32_bf16 a[68:71], v[132:135], v[244:247], a[68:71]
    ds_read_b64_tr_b16 v[122:123], v26 offset:28864
    v_mfma_f32_16x16x32_bf16 a[72:75], v[104:107], v[240:243], a[72:75]
    ds_read_b64_tr_b16 v[124:125], v72 offset:46336
    v_mfma_f32_16x16x32_bf16 a[76:79], v[104:107], v[244:247], a[76:79]
    s_waitcnt lgkmcnt(5)
    ds_read_b64_tr_b16 v[126:127], v72 offset:46592
    v_mfma_f32_16x16x32_bf16 a[80:83], v[108:111], v[240:243], a[80:83]
    ds_read_b64_tr_b16 v[128:129], v26 offset:37888
    s_add_u32 s21, s90, 2
    s_mov_b32 s13, 104192
    s_add_u32 s12, s91, 2
    s_cmp_ge_u32 s3, 1
    s_cselect_b32 s21, s12, s21
    s_cselect_b32 s13, 113664, s13
    s_mov_b32 s12, 16
    s_cmp_ge_u32 s3, 2
    s_cselect_b32 s21, s12, s21
    s_cselect_b32 s13, 123136, s13
    s_mov_b32 s12, 17
    s_cmp_ge_u32 s3, 3
    s_cselect_b32 s21, s12, s21
    s_cselect_b32 s13, 132608, s13
    s_mov_b32 m0, s13
    s_mul_i32 s20, s21, 36864
    s_add_u32 s20, s20, s0
    buffer_load_dwordx4 v68, s[48:51], s20 offen offset:0 lds
    v_mfma_f32_16x16x32_bf16 a[84:87], v[108:111], v[244:247], a[84:87]
    ds_read_b64_tr_b16 v[130:131], v26 offset:38144
    v_mfma_f32_16x16x32_bf16 a[88:91], v[112:115], v[240:243], a[88:91]
    ds_read_b64_tr_b16 v[132:133], v26 offset:37920
    v_mfma_f32_16x16x32_bf16 a[92:95], v[112:115], v[244:247], a[92:95]
    s_waitcnt lgkmcnt(5)
    ds_read_b64_tr_b16 v[134:135], v26 offset:38176
    v_mfma_f32_16x16x32_bf16 a[96:99], v[116:119], v[240:243], a[96:99]
    ds_read_b64_tr_b16 v[104:105], v26 offset:37952
    buffer_load_dwordx4 v69, s[48:51], s20 offen offset:1056 lds
    v_mfma_f32_16x16x32_bf16 a[100:103], v[116:119], v[244:247], a[100:103]
    ds_read_b64_tr_b16 v[106:107], v26 offset:38208
    v_mfma_f32_16x16x32_bf16 a[104:107], v[120:123], v[240:243], a[104:107]
    ds_read_b64_tr_b16 v[108:109], v26 offset:37984
    v_mfma_f32_16x16x32_bf16 a[108:111], v[120:123], v[244:247], a[108:111]
    s_waitcnt lgkmcnt(5)
    ds_read_b64_tr_b16 v[110:111], v26 offset:38240
    v_mfma_f32_16x16x32_bf16 a[48:51], v[124:127], a[144:147], a[48:51]
    ds_read_b64_tr_b16 v[112:113], v26 offset:38016
    buffer_load_dwordx4 v70, s[48:51], s20 offen offset:2112 lds
    v_mfma_f32_16x16x32_bf16 a[52:55], v[124:127], a[148:151], a[52:55]
    ds_read_b64_tr_b16 v[114:115], v26 offset:38272
    v_mfma_f32_16x16x32_bf16 a[56:59], v[128:131], a[144:147], a[56:59]
    ds_read_b64_tr_b16 v[116:117], v26 offset:38048
    v_mfma_f32_16x16x32_bf16 a[60:63], v[128:131], a[148:151], a[60:63]
    s_waitcnt lgkmcnt(5)
    ds_read_b64_tr_b16 v[118:119], v26 offset:38304
    v_mfma_f32_16x16x32_bf16 a[64:67], v[132:135], a[144:147], a[64:67]
    ds_read_b64_tr_b16 v[120:121], v26 offset:38080
    s_waitcnt vmcnt(15)
    buffer_store_dwordx2 v[24:25], v19, s[52:55], s22 offen offset:416 sc1
    v_mfma_f32_16x16x32_bf16 a[68:71], v[132:135], a[148:151], a[68:71]
    ds_read_b64_tr_b16 v[122:123], v26 offset:38336
    buffer_load_dwordx4 v71, s[48:51], s20 offen offset:3168 lds
    v_mfma_f32_16x16x32_bf16 a[72:75], v[104:107], a[144:147], a[72:75]
    ds_read_b64_tr_b16 v[124:125], v72 offset:55808
    v_mfma_f32_16x16x32_bf16 a[76:79], v[104:107], a[148:151], a[76:79]
    s_waitcnt lgkmcnt(5)
    ds_read_b64_tr_b16 v[126:127], v72 offset:56064
    v_mfma_f32_16x16x32_bf16 a[80:83], v[108:111], a[144:147], a[80:83]
    ds_read_b64_tr_b16 v[128:129], v26 offset:47360
    v_mfma_f32_16x16x32_bf16 a[84:87], v[108:111], a[148:151], a[84:87]
    ds_read_b64_tr_b16 v[130:131], v26 offset:47616
    s_add_u32 m0, m0, 4224
    s_add_u32 s20, s20, 4608
    buffer_load_dwordx4 v68, s[48:51], s20 offen offset:0 lds
    v_mfma_f32_16x16x32_bf16 a[88:91], v[112:115], a[144:147], a[88:91]
    ds_read_b64_tr_b16 v[132:133], v26 offset:47392
    v_mfma_f32_16x16x32_bf16 a[92:95], v[112:115], a[148:151], a[92:95]
    s_waitcnt lgkmcnt(5)
    ds_read_b64_tr_b16 v[134:135], v26 offset:47648
    v_mfma_f32_16x16x32_bf16 a[96:99], v[116:119], a[144:147], a[96:99]
    ds_read_b64_tr_b16 v[104:105], v26 offset:47424
    v_mfma_f32_16x16x32_bf16 a[100:103], v[116:119], a[148:151], a[100:103]
    ds_read_b64_tr_b16 v[106:107], v26 offset:47680
    v_mfma_f32_16x16x32_bf16 a[104:107], v[120:123], a[144:147], a[104:107]
    ds_read_b64_tr_b16 v[108:109], v26 offset:47456
    buffer_load_dwordx4 v69, s[48:51], s20 offen offset:1056 lds
    v_mfma_f32_16x16x32_bf16 a[108:111], v[120:123], a[148:151], a[108:111]
    s_waitcnt lgkmcnt(5)
    ds_read_b64_tr_b16 v[110:111], v26 offset:47712
    v_mfma_f32_16x16x32_bf16 a[48:51], v[124:127], a[152:155], a[48:51]
    ds_read_b64_tr_b16 v[112:113], v26 offset:47488
    v_mfma_f32_16x16x32_bf16 a[52:55], v[124:127], a[156:159], a[52:55]
    ds_read_b64_tr_b16 v[114:115], v26 offset:47744
    v_mfma_f32_16x16x32_bf16 a[56:59], v[128:131], a[152:155], a[56:59]
    ds_read_b64_tr_b16 v[116:117], v26 offset:47520
    buffer_load_dwordx4 v70, s[48:51], s20 offen offset:2112 lds
    v_mfma_f32_16x16x32_bf16 a[60:63], v[128:131], a[156:159], a[60:63]
    s_waitcnt lgkmcnt(5)
    ds_read_b64_tr_b16 v[118:119], v26 offset:47776
    v_mfma_f32_16x16x32_bf16 a[64:67], v[132:135], a[152:155], a[64:67]
    ds_read_b64_tr_b16 v[120:121], v26 offset:47552
    v_mfma_f32_16x16x32_bf16 a[68:71], v[132:135], a[156:159], a[68:71]
    ds_read_b64_tr_b16 v[122:123], v26 offset:47808
    v_mfma_f32_16x16x32_bf16 a[72:75], v[104:107], a[152:155], a[72:75]
    ds_read_b64_tr_b16 v[124:125], v72 offset:65280
    v_mfma_f32_16x16x32_bf16 a[76:79], v[104:107], a[156:159], a[76:79]
    s_waitcnt lgkmcnt(5)
    ds_read_b64_tr_b16 v[126:127], v73 offset:0
    buffer_load_dwordx4 v71, s[48:51], s20 offen offset:3168 lds
    v_mfma_f32_16x16x32_bf16 a[80:83], v[108:111], a[152:155], a[80:83]
    ds_read_b64_tr_b16 v[128:129], v26 offset:56832
    v_mfma_f32_16x16x32_bf16 a[84:87], v[108:111], a[156:159], a[84:87]
    ds_read_b64_tr_b16 v[130:131], v26 offset:57088
    v_mfma_f32_16x16x32_bf16 a[88:91], v[112:115], a[152:155], a[88:91]
    ds_read_b64_tr_b16 v[132:133], v26 offset:56864
    v_mfma_f32_16x16x32_bf16 a[92:95], v[112:115], a[156:159], a[92:95]
    s_waitcnt lgkmcnt(5)
    ds_read_b64_tr_b16 v[134:135], v26 offset:57120
    s_add_u32 m0, m0, 4224
    s_lshl_b32 s21, s21, 10
    s_add_u32 s21, s21, s30
    s_add_u32 s21, s21, 589824
    buffer_load_dwordx4 v10, s[52:55], s21 offen sc1 lds
    v_mfma_f32_16x16x32_bf16 a[96:99], v[116:119], a[152:155], a[96:99]
    ds_read_b64_tr_b16 v[104:105], v26 offset:56896
    v_mfma_f32_16x16x32_bf16 a[100:103], v[116:119], a[156:159], a[100:103]
    ds_read_b64_tr_b16 v[106:107], v26 offset:57152
    v_mfma_f32_16x16x32_bf16 a[104:107], v[120:123], a[152:155], a[104:107]
    ds_read_b64_tr_b16 v[108:109], v26 offset:56928
    v_mfma_f32_16x16x32_bf16 a[108:111], v[120:123], a[156:159], a[108:111]
    s_waitcnt lgkmcnt(5)
    ds_read_b64_tr_b16 v[110:111], v26 offset:57184
    v_mfma_f32_16x16x32_bf16 a[48:51], v[124:127], a[160:163], a[48:51]
    ds_read_b64_tr_b16 v[112:113], v26 offset:56960
    s_waitcnt vmcnt(12)
    v_cmp_ne_u64 vcc, v[20:21], v[24:25]
    s_and_b32 s12, vcc_lo, 0xf
    s_cbranch_scc0 poll_8_ok
    s_mov_b32 s14, 0
poll_8:
    s_sleep 3
    buffer_load_dwordx2 v[20:21], v22, s[52:55], 0 offen offset:256 sc1
    s_add_u32 s14, s14, 1
    s_cmp_gt_u32 s14, 0x8000
    s_cbranch_scc1 poll_8_ok
    s_waitcnt vmcnt(0)
    v_cmp_ne_u64 vcc, v[20:21], v[24:25]
    s_and_b32 s12, vcc_lo, 0xf
    s_cbranch_scc1 poll_8
poll_8_ok:

    v_mfma_f32_16x16x32_bf16 a[52:55], v[124:127], a[164:167], a[52:55]
    ds_read_b64_tr_b16 v[114:115], v26 offset:57216
    buffer_load_dwordx4 a[200:203], v10, s[52:55], s93 offen offset:2048 sc1
    buffer_load_dwordx4 a[204:207], v12, s[52:55], s93 offen offset:2048 sc1
    v_mfma_f32_16x16x32_bf16 a[56:59], v[128:131], a[160:163], a[56:59]
    ds_read_b64_tr_b16 v[116:117], v26 offset:56992
    v_mfma_f32_16x16x32_bf16 a[60:63], v[128:131], a[164:167], a[60:63]
    s_waitcnt lgkmcnt(5)
    ds_read_b64_tr_b16 v[118:119], v26 offset:57248
    buffer_load_dwordx4 a[208:211], v10, s[52:55], s94 offen offset:2048 sc1
    buffer_load_dwordx4 a[212:215], v12, s[52:55], s94 offen offset:2048 sc1
    v_mfma_f32_16x16x32_bf16 a[64:67], v[132:135], a[160:163], a[64:67]
    ds_read_b64_tr_b16 v[120:121], v26 offset:57024
    buffer_load_dwordx4 a[216:219], v10, s[52:55], s95 offen offset:2048 sc1
    buffer_load_dwordx4 a[220:223], v12, s[52:55], s95 offen offset:2048 sc1
    v_mfma_f32_16x16x32_bf16 a[68:71], v[132:135], a[164:167], a[68:71]
    ds_read_b64_tr_b16 v[122:123], v26 offset:57280
    v_mfma_f32_16x16x32_bf16 a[72:75], v[104:107], a[160:163], a[72:75]
    v_mfma_f32_16x16x32_bf16 a[76:79], v[104:107], a[164:167], a[76:79]
    s_waitcnt lgkmcnt(4)
    v_mfma_f32_16x16x32_bf16 a[80:83], v[108:111], a[160:163], a[80:83]
    v_mfma_f32_16x16x32_bf16 a[84:87], v[108:111], a[164:167], a[84:87]
    v_mfma_f32_16x16x32_bf16 a[88:91], v[112:115], a[160:163], a[88:91]
    v_mfma_f32_16x16x32_bf16 a[92:95], v[112:115], a[164:167], a[92:95]
    s_waitcnt lgkmcnt(0)
    v_mfma_f32_16x16x32_bf16 a[96:99], v[116:119], a[160:163], a[96:99]
    v_mfma_f32_16x16x32_bf16 a[100:103], v[116:119], a[164:167], a[100:103]
    v_mfma_f32_16x16x32_bf16 a[104:107], v[120:123], a[160:163], a[104:107]
    v_mfma_f32_16x16x32_bf16 a[108:111], v[120:123], a[164:167], a[108:111]
    s_waitcnt vmcnt(6)
    s_barrier
    ds_read_b64_tr_b16 v[124:125], v73 offset:9216
    ds_read_b64_tr_b16 v[126:127], v73 offset:9472
    ds_read_b64_tr_b16 v[128:129], v27 offset:768
    ds_read_b64_tr_b16 v[130:131], v27 offset:1024
    ds_read_b64_tr_b16 v[132:133], v27 offset:800
    ds_read_b64_tr_b16 v[134:135], v27 offset:1056
    ds_read_b64_tr_b16 v[104:105], v27 offset:832
    ds_read_b64_tr_b16 v[106:107], v27 offset:1088
    ds_read_b64_tr_b16 v[108:109], v27 offset:864
    ds_read_b64_tr_b16 v[110:111], v27 offset:1120
    s_waitcnt lgkmcnt(8)
    v_mfma_f32_16x16x32_bf16 a[48:51], v[124:127], a[168:171], a[48:51]
    ds_read_b64_tr_b16 v[112:113], v27 offset:896
    s_add_u32 s21, s89, 3
    s_mov_b32 s13, 142080
    s_add_u32 s12, s90, 3
    s_cmp_ge_u32 s3, 1
    s_cselect_b32 s21, s12, s21
    s_cselect_b32 s13, 151552, s13
    s_add_u32 s12, s91, 3
    s_cmp_ge_u32 s3, 2
    s_cselect_b32 s21, s12, s21
    s_cselect_b32 s13, 0, s13
    s_mov_b32 m0, s13
    s_mul_i32 s20, s21, 36864
    s_add_u32 s20, s20, s0
    buffer_load_dwordx4 v68, s[48:51], s20 offen offset:0 lds
    v_mfma_f32_16x16x32_bf16 a[52:55], v[124:127], a[172:175], a[52:55]
    s_waitcnt lgkmcnt(5)
    ds_read_b64_tr_b16 v[114:115], v27 offset:1152
    v_mfma_f32_16x16x32_bf16 a[56:59], v[128:131], a[168:171], a[56:59]
    ds_read_b64_tr_b16 v[116:117], v27 offset:928
    buffer_load_dwordx4 v69, s[48:51], s20 offen offset:1056 lds
    v_mfma_f32_16x16x32_bf16 a[60:63], v[128:131], a[172:175], a[60:63]
    ds_read_b64_tr_b16 v[118:119], v27 offset:1184
    v_mfma_f32_16x16x32_bf16 a[64:67], v[132:135], a[168:171], a[64:67]
    ds_read_b64_tr_b16 v[120:121], v27 offset:960
    v_mfma_f32_16x16x32_bf16 a[68:71], v[132:135], a[172:175], a[68:71]
    s_waitcnt lgkmcnt(5)
    ds_read_b64_tr_b16 v[122:123], v27 offset:1216
    buffer_load_dwordx4 v70, s[48:51], s20 offen offset:2112 lds
    v_mfma_f32_16x16x32_bf16 a[72:75], v[104:107], a[168:171], a[72:75]
    ds_read_b64_tr_b16 v[124:125], v73 offset:18688
    v_mfma_f32_16x16x32_bf16 a[76:79], v[104:107], a[172:175], a[76:79]
    ds_read_b64_tr_b16 v[126:127], v73 offset:18944
    v_mfma_f32_16x16x32_bf16 a[80:83], v[108:111], a[168:171], a[80:83]
    ds_read_b64_tr_b16 v[128:129], v27 offset:10240
    buffer_load_dwordx4 v71, s[48:51], s20 offen offset:3168 lds
    v_mfma_f32_16x16x32_bf16 a[84:87], v[108:111], a[172:175], a[84:87]
    s_waitcnt lgkmcnt(5)
    ds_read_b64_tr_b16 v[130:131], v27 offset:10496
    v_mfma_f32_16x16x32_bf16 a[88:91], v[112:115], a[168:171], a[88:91]
    ds_read_b64_tr_b16 v[132:133], v27 offset:10272
    s_add_u32 m0, m0, 4224
    s_add_u32 s20, s20, 4608
    buffer_load_dwordx4 v68, s[48:51], s20 offen offset:0 lds
    v_mfma_f32_16x16x32_bf16 a[92:95], v[112:115], a[172:175], a[92:95]
    ds_read_b64_tr_b16 v[134:135], v27 offset:10528
    v_mfma_f32_16x16x32_bf16 a[96:99], v[116:119], a[168:171], a[96:99]
    ds_read_b64_tr_b16 v[104:105], v27 offset:10304
    buffer_load_dwordx2 v[20:21], v22, s[52:55], 0 offen offset:384 sc1
    v_mfma_f32_16x16x32_bf16 a[100:103], v[116:119], a[172:175], a[100:103]
    s_waitcnt lgkmcnt(5)
    ds_read_b64_tr_b16 v[106:107], v27 offset:10560
    buffer_load_dwordx4 v69, s[48:51], s20 offen offset:1056 lds
    v_mfma_f32_16x16x32_bf16 a[104:107], v[120:123], a[168:171], a[104:107]
    ds_read_b64_tr_b16 v[108:109], v27 offset:10336
    v_mfma_f32_16x16x32_bf16 a[108:111], v[120:123], a[172:175], a[108:111]
    ds_read_b64_tr_b16 v[110:111], v27 offset:10592
    v_mfma_f32_16x16x32_bf16 a[48:51], v[124:127], a[176:179], a[48:51]
    ds_read_b64_tr_b16 v[112:113], v27 offset:10368
    buffer_load_dwordx4 v70, s[48:51], s20 offen offset:2112 lds
    v_mfma_f32_16x16x32_bf16 a[52:55], v[124:127], a[180:183], a[52:55]
    s_waitcnt lgkmcnt(5)
    ds_read_b64_tr_b16 v[114:115], v27 offset:10624
    v_mfma_f32_16x16x32_bf16 a[56:59], v[128:131], a[176:179], a[56:59]
    ds_read_b64_tr_b16 v[116:117], v27 offset:10400
    buffer_load_dwordx4 v71, s[48:51], s20 offen offset:3168 lds
    v_mfma_f32_16x16x32_bf16 a[60:63], v[128:131], a[180:183], a[60:63]
    ds_read_b64_tr_b16 v[118:119], v27 offset:10656
    v_mfma_f32_16x16x32_bf16 a[64:67], v[132:135], a[176:179], a[64:67]
    ds_read_b64_tr_b16 v[120:121], v27 offset:10432
    v_mfma_f32_16x16x32_bf16 a[68:71], v[132:135], a[180:183], a[68:71]
    s_waitcnt lgkmcnt(5)
    ds_read_b64_tr_b16 v[122:123], v27 offset:10688
    s_add_u32 m0, m0, 4224
    s_lshl_b32 s21, s21, 10
    s_add_u32 s21, s21, s30
    s_add_u32 s21, s21, 589824
    buffer_load_dwordx4 v10, s[52:55], s21 offen sc1 lds
    v_mfma_f32_16x16x32_bf16 a[72:75], v[104:107], a[176:179], a[72:75]
    ds_read_b64_tr_b16 v[124:125], v73 offset:28160
    v_mfma_f32_16x16x32_bf16 a[76:79], v[104:107], a[180:183], a[76:79]
    ds_read_b64_tr_b16 v[126:127], v73 offset:28416
    v_mfma_f32_16x16x32_bf16 a[80:83], v[108:111], a[176:179], a[80:83]
    ds_read_b64_tr_b16 v[128:129], v27 offset:19712
    v_mfma_f32_16x16x32_bf16 a[84:87], v[108:111], a[180:183], a[84:87]
    s_waitcnt lgkmcnt(5)
    ds_read_b64_tr_b16 v[130:131], v27 offset:19968
    v_mfma_f32_16x16x32_bf16 a[88:91], v[112:115], a[176:179], a[88:91]
    ds_read_b64_tr_b16 v[132:133], v27 offset:19744
    v_mfma_f32_16x16x32_bf16 a[92:95], v[112:115], a[180:183], a[92:95]
    ds_read_b64_tr_b16 v[134:135], v27 offset:20000
    v_mfma_f32_16x16x32_bf16 a[96:99], v[116:119], a[176:179], a[96:99]
    ds_read_b64_tr_b16 v[104:105], v27 offset:19776
    v_mfma_f32_16x16x32_bf16 a[100:103], v[116:119], a[180:183], a[100:103]
    s_waitcnt lgkmcnt(5)
    ds_read_b64_tr_b16 v[106:107], v27 offset:20032
    v_mfma_f32_16x16x32_bf16 a[104:107], v[120:123], a[176:179], a[104:107]
    ds_read_b64_tr_b16 v[108:109], v27 offset:19808
    v_mfma_f32_16x16x32_bf16 a[108:111], v[120:123], a[180:183], a[108:111]
    ds_read_b64_tr_b16 v[110:111], v27 offset:20064
    v_mfma_f32_16x16x32_bf16 a[48:51], v[124:127], a[184:187], a[48:51]
    ds_read_b64_tr_b16 v[112:113], v27 offset:19840
    v_mfma_f32_16x16x32_bf16 a[52:55], v[124:127], a[188:191], a[52:55]
    s_waitcnt lgkmcnt(5)
    ds_read_b64_tr_b16 v[114:115], v27 offset:20096
    v_mfma_f32_16x16x32_bf16 a[56:59], v[128:131], a[184:187], a[56:59]
    ds_read_b64_tr_b16 v[116:117], v27 offset:19872
    v_mfma_f32_16x16x32_bf16 a[60:63], v[128:131], a[188:191], a[60:63]
    ds_read_b64_tr_b16 v[118:119], v27 offset:20128
    v_mfma_f32_16x16x32_bf16 a[64:67], v[132:135], a[184:187], a[64:67]
    ds_read_b64_tr_b16 v[120:121], v27 offset:19904
    v_mfma_f32_16x16x32_bf16 a[68:71], v[132:135], a[188:191], a[68:71]
    s_waitcnt lgkmcnt(5)
    ds_read_b64_tr_b16 v[122:123], v27 offset:20160
    v_mfma_f32_16x16x32_bf16 a[72:75], v[104:107], a[184:187], a[72:75]
    ds_read_b64_tr_b16 v[124:125], v73 offset:37632
    v_mfma_f32_16x16x32_bf16 a[76:79], v[104:107], a[188:191], a[76:79]
    ds_read_b64_tr_b16 v[126:127], v73 offset:37888
    v_mfma_f32_16x16x32_bf16 a[80:83], v[108:111], a[184:187], a[80:83]
    ds_read_b64_tr_b16 v[128:129], v27 offset:29184
    s_waitcnt vmcnt(4)
    v_cmp_ne_u64 vcc, v[20:21], v[24:25]
    s_and_b32 s12, vcc_lo, 0xf
    s_cbranch_scc0 poll_9_ok
    s_mov_b32 s14, 0
poll_9:
    s_sleep 3
    buffer_load_dwordx2 v[20:21], v22, s[52:55], 0 offen offset:384 sc1
    s_add_u32 s14, s14, 1
    s_cmp_gt_u32 s14, 0x8000
    s_cbranch_scc1 poll_9_ok
    s_waitcnt vmcnt(0)
    v_cmp_ne_u64 vcc, v[20:21], v[24:25]
    s_and_b32 s12, vcc_lo, 0xf
    s_cbranch_scc1 poll_9
poll_9_ok:

    v_mfma_f32_16x16x32_bf16 a[84:87], v[108:111], a[188:191], a[84:87]
    s_waitcnt lgkmcnt(5)
    ds_read_b64_tr_b16 v[130:131], v27 offset:29440
    buffer_load_dwordx4 a[0:3], v10, s[52:55], s93 offen offset:3072 sc1
    buffer_load_dwordx4 a[4:7], v12, s[52:55], s93 offen offset:3072 sc1
    v_mfma_f32_16x16x32_bf16 a[88:91], v[112:115], a[184:187], a[88:91]
    ds_read_b64_tr_b16 v[132:133], v27 offset:29216
    v_mfma_f32_16x16x32_bf16 a[92:95], v[112:115], a[188:191], a[92:95]
    ds_read_b64_tr_b16 v[134:135], v27 offset:29472
    buffer_load_dwordx4 a[8:11], v10, s[52:55], s94 offen offset:3072 sc1
    buffer_load_dwordx4 a[12:15], v12, s[52:55], s94 offen offset:3072 sc1
    v_mfma_f32_16x16x32_bf16 a[96:99], v[116:119], a[184:187], a[96:99]
    ds_read_b64_tr_b16 v[104:105], v27 offset:29248
    v_mfma_f32_16x16x32_bf16 a[100:103], v[116:119], a[188:191], a[100:103]
    s_waitcnt lgkmcnt(5)
    ds_read_b64_tr_b16 v[106:107], v27 offset:29504
    buffer_load_dwordx4 a[16:19], v10, s[52:55], s95 offen offset:3072 sc1
    buffer_load_dwordx4 a[20:23], v12, s[52:55], s95 offen offset:3072 sc1
    v_mfma_f32_16x16x32_bf16 a[104:107], v[120:123], a[184:187], a[104:107]
    ds_read_b64_tr_b16 v[108:109], v27 offset:29280
    v_cmp_ne_u64 vcc, v[20:21], v[24:25]
    s_and_b32 s12, vcc_lo, 0xf0
    s_cbranch_scc0 poll_10_ok
    s_mov_b32 s14, 0
poll_10:
    s_sleep 3
    buffer_load_dwordx2 v[20:21], v22, s[52:55], 0 offen offset:384 sc1
    s_add_u32 s14, s14, 1
    s_cmp_gt_u32 s14, 0x8000
    s_cbranch_scc1 poll_10_ok
    s_waitcnt vmcnt(0)
    v_cmp_ne_u64 vcc, v[20:21], v[24:25]
    s_and_b32 s12, vcc_lo, 0xf0
    s_cbranch_scc1 poll_10
poll_10_ok:

    v_mfma_f32_16x16x32_bf16 a[108:111], v[120:123], a[188:191], a[108:111]
    ds_read_b64_tr_b16 v[110:111], v27 offset:29536
    v_mfma_f32_16x16x32_bf16 a[48:51], v[124:127], a[200:203], a[48:51]
    ds_read_b64_tr_b16 v[112:113], v27 offset:29312
    s_add_u32 s12, s1, 16384
    buffer_load_dwordx4 a[240:243], v10, s[52:55], s12 offen offset:0 sc1
    buffer_load_dwordx4 a[244:247], v12, s[52:55], s12 offen offset:0 sc1
    v_mfma_f32_16x16x32_bf16 a[52:55], v[124:127], a[204:207], a[52:55]
    s_waitcnt lgkmcnt(5)
    ds_read_b64_tr_b16 v[114:115], v27 offset:29568
    v_mfma_f32_16x16x32_bf16 a[56:59], v[128:131], a[200:203], a[56:59]
    ds_read_b64_tr_b16 v[116:117], v27 offset:29344
    s_add_u32 s12, s1, 17408
    buffer_load_dwordx4 a[248:251], v10, s[52:55], s12 offen offset:0 sc1
    buffer_load_dwordx4 a[252:255], v12, s[52:55], s12 offen offset:0 sc1
    v_mfma_f32_16x16x32_bf16 a[60:63], v[128:131], a[204:207], a[60:63]
    ds_read_b64_tr_b16 v[118:119], v27 offset:29600
    v_mfma_f32_16x16x32_bf16 a[64:67], v[132:135], a[200:203], a[64:67]
    ds_read_b64_tr_b16 v[120:121], v27 offset:29376
    v_mfma_f32_16x16x32_bf16 a[68:71], v[132:135], a[204:207], a[68:71]
    s_waitcnt lgkmcnt(5)
    ds_read_b64_tr_b16 v[122:123], v27 offset:29632
    v_mfma_f32_16x16x32_bf16 a[72:75], v[104:107], a[200:203], a[72:75]
    ds_read_b64_tr_b16 v[124:125], v73 offset:47104
    v_mfma_f32_16x16x32_bf16 a[76:79], v[104:107], a[204:207], a[76:79]
    ds_read_b64_tr_b16 v[126:127], v73 offset:47360
    v_mfma_f32_16x16x32_bf16 a[80:83], v[108:111], a[200:203], a[80:83]
    ds_read_b64_tr_b16 v[128:129], v27 offset:38656
    v_mfma_f32_16x16x32_bf16 a[84:87], v[108:111], a[204:207], a[84:87]
    s_waitcnt lgkmcnt(5)
    ds_read_b64_tr_b16 v[130:131], v27 offset:38912
    v_mfma_f32_16x16x32_bf16 a[88:91], v[112:115], a[200:203], a[88:91]
    ds_read_b64_tr_b16 v[132:133], v27 offset:38688
    v_mfma_f32_16x16x32_bf16 a[92:95], v[112:115], a[204:207], a[92:95]
    ds_read_b64_tr_b16 v[134:135], v27 offset:38944
    v_mfma_f32_16x16x32_bf16 a[96:99], v[116:119], a[200:203], a[96:99]
    ds_read_b64_tr_b16 v[104:105], v27 offset:38720
    s_lshl_b32 s12, s8, 3
    s_add_u32 s12, s12, s4
    s_lshl_b32 s12, s12, 9
    s_add_u32 s12, s12, s27
    s_add_u32 s13, s12, 18432

    buffer_load_dwordx2 v[224:225], v23, s[52:55], s12 offen sc1
    buffer_load_dwordx2 v[226:227], v23, s[52:55], s13 offen sc1
    s_add_u32 s12, s8, 32
    s_lshl_b32 s12, s12, 9
    s_lshl_b32 s13, s9, 3
    s_add_u32 s13, s13, s4
    s_mul_i32 s13, s13, 18432
    s_add_u32 s12, s12, s13
    s_add_u32 s12, s12, 1179648

    buffer_load_dwordx2 v[228:229], v23, s[52:55], s12 offen sc1
    v_mfma_f32_16x16x32_bf16 a[100:103], v[116:119], a[204:207], a[100:103]
    s_waitcnt lgkmcnt(5)
    ds_read_b64_tr_b16 v[106:107], v27 offset:38976
    v_mfma_f32_16x16x32_bf16 a[104:107], v[120:123], a[200:203], a[104:107]
    ds_read_b64_tr_b16 v[108:109], v27 offset:38752
    v_mfma_f32_16x16x32_bf16 a[108:111], v[120:123], a[204:207], a[108:111]
    ds_read_b64_tr_b16 v[110:111], v27 offset:39008
    v_mfma_f32_16x16x32_bf16 a[48:51], v[124:127], a[208:211], a[48:51]
    ds_read_b64_tr_b16 v[112:113], v27 offset:38784
    v_mfma_f32_16x16x32_bf16 a[52:55], v[124:127], a[212:215], a[52:55]
    s_waitcnt lgkmcnt(5)
    ds_read_b64_tr_b16 v[114:115], v27 offset:39040
    v_mfma_f32_16x16x32_bf16 a[56:59], v[128:131], a[208:211], a[56:59]
    ds_read_b64_tr_b16 v[116:117], v27 offset:38816
    v_mfma_f32_16x16x32_bf16 a[60:63], v[128:131], a[212:215], a[60:63]
    ds_read_b64_tr_b16 v[118:119], v27 offset:39072
    v_mfma_f32_16x16x32_bf16 a[64:67], v[132:135], a[208:211], a[64:67]
    ds_read_b64_tr_b16 v[120:121], v27 offset:38848
    v_mfma_f32_16x16x32_bf16 a[68:71], v[132:135], a[212:215], a[68:71]
    s_waitcnt lgkmcnt(5)
    ds_read_b64_tr_b16 v[122:123], v27 offset:39104
    v_mfma_f32_16x16x32_bf16 a[72:75], v[104:107], a[208:211], a[72:75]
    ds_read_b64_tr_b16 v[124:125], v73 offset:56576
    v_mfma_f32_16x16x32_bf16 a[76:79], v[104:107], a[212:215], a[76:79]
    ds_read_b64_tr_b16 v[126:127], v73 offset:56832
    v_mfma_f32_16x16x32_bf16 a[80:83], v[108:111], a[208:211], a[80:83]
    ds_read_b64_tr_b16 v[128:129], v27 offset:48128
    v_mfma_f32_16x16x32_bf16 a[84:87], v[108:111], a[212:215], a[84:87]
    s_waitcnt lgkmcnt(5)
    ds_read_b64_tr_b16 v[130:131], v27 offset:48384
    v_mfma_f32_16x16x32_bf16 a[88:91], v[112:115], a[208:211], a[88:91]
    ds_read_b64_tr_b16 v[132:133], v27 offset:48160
    v_mfma_f32_16x16x32_bf16 a[92:95], v[112:115], a[212:215], a[92:95]
    ds_read_b64_tr_b16 v[134:135], v27 offset:48416
    v_mfma_f32_16x16x32_bf16 a[96:99], v[116:119], a[208:211], a[96:99]
    ds_read_b64_tr_b16 v[104:105], v27 offset:48192
    v_mfma_f32_16x16x32_bf16 a[100:103], v[116:119], a[212:215], a[100:103]
    s_waitcnt lgkmcnt(5)
    ds_read_b64_tr_b16 v[106:107], v27 offset:48448
    v_mfma_f32_16x16x32_bf16 a[104:107], v[120:123], a[208:211], a[104:107]
    ds_read_b64_tr_b16 v[108:109], v27 offset:48224
    v_mfma_f32_16x16x32_bf16 a[108:111], v[120:123], a[212:215], a[108:111]
    ds_read_b64_tr_b16 v[110:111], v27 offset:48480
    v_mfma_f32_16x16x32_bf16 a[48:51], v[124:127], a[216:219], a[48:51]
    ds_read_b64_tr_b16 v[112:113], v27 offset:48256
    v_mfma_f32_16x16x32_bf16 a[52:55], v[124:127], a[220:223], a[52:55]
    s_waitcnt lgkmcnt(5)
    ds_read_b64_tr_b16 v[114:115], v27 offset:48512
    v_mfma_f32_16x16x32_bf16 a[56:59], v[128:131], a[216:219], a[56:59]
    ds_read_b64_tr_b16 v[116:117], v27 offset:48288
    v_mfma_f32_16x16x32_bf16 a[60:63], v[128:131], a[220:223], a[60:63]
    ds_read_b64_tr_b16 v[118:119], v27 offset:48544
    v_mfma_f32_16x16x32_bf16 a[64:67], v[132:135], a[216:219], a[64:67]
    ds_read_b64_tr_b16 v[120:121], v27 offset:48320
    v_mfma_f32_16x16x32_bf16 a[68:71], v[132:135], a[220:223], a[68:71]
    s_waitcnt lgkmcnt(5)
    ds_read_b64_tr_b16 v[122:123], v27 offset:48576
    v_mfma_f32_16x16x32_bf16 a[72:75], v[104:107], a[216:219], a[72:75]
    v_mfma_f32_16x16x32_bf16 a[76:79], v[104:107], a[220:223], a[76:79]
    v_mfma_f32_16x16x32_bf16 a[80:83], v[108:111], a[216:219], a[80:83]
    v_mfma_f32_16x16x32_bf16 a[84:87], v[108:111], a[220:223], a[84:87]
    s_waitcnt lgkmcnt(2)
    v_mfma_f32_16x16x32_bf16 a[88:91], v[112:115], a[216:219], a[88:91]
    v_mfma_f32_16x16x32_bf16 a[92:95], v[112:115], a[220:223], a[92:95]
    v_mfma_f32_16x16x32_bf16 a[96:99], v[116:119], a[216:219], a[96:99]
    v_mfma_f32_16x16x32_bf16 a[100:103], v[116:119], a[220:223], a[100:103]
    s_waitcnt lgkmcnt(0)
    v_mfma_f32_16x16x32_bf16 a[104:107], v[120:123], a[216:219], a[104:107]
    v_mfma_f32_16x16x32_bf16 a[108:111], v[120:123], a[220:223], a[108:111]
    s_mov_b32 s28, 524288
    s_mov_b32 s29, 524288
    s_waitcnt vmcnt(13)
    s_barrier
    ds_read_b64_tr_b16 v[124:125], v74 offset:512
    ds_read_b64_tr_b16 v[126:127], v74 offset:768
    ds_read_b64_tr_b16 v[128:129], v74 offset:9984
    ds_read_b64_tr_b16 v[130:131], v74 offset:10240
    ds_read_b64_tr_b16 v[132:133], v74 offset:19456
    ds_read_b64_tr_b16 v[134:135], v74 offset:19712
    ds_read_b64_tr_b16 v[104:105], v74 offset:28928
    ds_read_b64_tr_b16 v[106:107], v74 offset:29184
    ds_read_b64_tr_b16 v[108:109], v72 offset:8448
    ds_read_b64_tr_b16 v[110:111], v72 offset:8704
    s_waitcnt lgkmcnt(8)
    s_waitcnt vmcnt(5)
    v_mfma_f32_16x16x32_bf16 a[48:51], v[124:127], a[240:243], a[48:51]
    ds_read_b64_tr_b16 v[112:113], v27 offset:57600
    v_mfma_f32_16x16x32_bf16 a[52:55], v[124:127], a[244:247], a[52:55]
    s_waitcnt lgkmcnt(5)
    s_waitcnt vmcnt(3)
    ds_read_b64_tr_b16 v[114:115], v27 offset:57856
    v_mfma_f32_16x16x32_bf16 a[48:51], v[128:131], a[248:251], a[48:51]
    ds_read_b64_tr_b16 v[116:117], v28 offset:1536
    v_mfma_f32_16x16x32_bf16 a[52:55], v[128:131], a[252:255], a[52:55]
    ds_read_b64_tr_b16 v[118:119], v28 offset:1792
    v_mfma_f32_16x16x32_bf16 a[48:51], v[132:135], a[0:3], a[48:51]
    ds_read_b64_tr_b16 v[120:121], v28 offset:11008
    v_mfma_f32_16x16x32_bf16 a[52:55], v[132:135], a[4:7], a[52:55]
    s_waitcnt lgkmcnt(5)
    ds_read_b64_tr_b16 v[122:123], v28 offset:11264
    v_mfma_f32_16x16x32_bf16 a[48:51], v[104:107], a[8:11], a[48:51]
    ds_read_b64_tr_b16 v[124:125], v28 offset:20480
    v_mfma_f32_16x16x32_bf16 a[52:55], v[104:107], a[12:15], a[52:55]
    ds_read_b64_tr_b16 v[126:127], v28 offset:20736
    v_mfma_f32_16x16x32_bf16 a[48:51], v[108:111], a[16:19], a[48:51]
    ds_read_b64_tr_b16 v[128:129], v26 offset:0
    v_mfma_f32_16x16x32_bf16 a[52:55], v[108:111], a[20:23], a[52:55]
    s_waitcnt lgkmcnt(5)
    ds_read_b64_tr_b16 v[130:131], v26 offset:256
    v_mfma_f32_16x16x32_bf16 a[56:59], v[112:115], a[240:243], a[56:59]
    ds_read_b64_tr_b16 v[132:133], v27 offset:57632
    v_mfma_f32_16x16x32_bf16 a[60:63], v[112:115], a[244:247], a[60:63]
    ds_read_b64_tr_b16 v[134:135], v27 offset:57888
    v_mfma_f32_16x16x32_bf16 a[56:59], v[116:119], a[248:251], a[56:59]
    ds_read_b64_tr_b16 v[104:105], v28 offset:1568
    v_mfma_f32_16x16x32_bf16 a[60:63], v[116:119], a[252:255], a[60:63]
    s_waitcnt lgkmcnt(5)
    ds_read_b64_tr_b16 v[106:107], v28 offset:1824
    v_mfma_f32_16x16x32_bf16 a[56:59], v[120:123], a[0:3], a[56:59]
    ds_read_b64_tr_b16 v[108:109], v28 offset:11040
    v_accvgpr_read_b32 v136, a48
    v_accvgpr_read_b32 v137, a49
    v_mfma_f32_16x16x32_bf16 a[60:63], v[120:123], a[4:7], a[60:63]
    ds_read_b64_tr_b16 v[110:111], v28 offset:11296
    v_accvgpr_read_b32 v138, a50
    v_accvgpr_read_b32 v139, a51
    v_mfma_f32_16x16x32_bf16 a[56:59], v[124:127], a[8:11], a[56:59]
    ds_read_b64_tr_b16 v[112:113], v28 offset:20512
    v_accvgpr_read_b32 v140, a52
    v_accvgpr_read_b32 v141, a53
    v_mfma_f32_16x16x32_bf16 a[60:63], v[124:127], a[12:15], a[60:63]
    s_waitcnt lgkmcnt(5)
    ds_read_b64_tr_b16 v[114:115], v28 offset:20768
    v_accvgpr_read_b32 v142, a54
    v_accvgpr_read_b32 v143, a55
    v_mfma_f32_16x16x32_bf16 a[56:59], v[128:131], a[16:19], a[56:59]
    ds_read_b64_tr_b16 v[116:117], v26 offset:32
    v_cvt_pk_bf16_f32 v152, v136, v137
    v_cvt_pk_bf16_f32 v153, v138, v139
    v_mfma_f32_16x16x32_bf16 a[60:63], v[128:131], a[20:23], a[60:63]
    ds_read_b64_tr_b16 v[118:119], v26 offset:288
    v_cvt_pk_bf16_f32 v154, v140, v141
    v_cvt_pk_bf16_f32 v155, v142, v143
    v_mfma_f32_16x16x32_bf16 a[64:67], v[132:135], a[240:243], a[64:67]
    ds_read_b64_tr_b16 v[120:121], v27 offset:57664
    buffer_store_dwordx4 v[152:155], v78, s[52:55], s28 offen sc1
    s_lshl_b32 s28, s4, 16
    s_add_u32 s28, s28, 65536
    s_and_b32 s28, s28, 0x7ffff
    v_mfma_f32_16x16x32_bf16 a[68:71], v[132:135], a[244:247], a[68:71]
    s_waitcnt lgkmcnt(5)
    ds_read_b64_tr_b16 v[122:123], v27 offset:57920
    v_mfma_f32_16x16x32_bf16 a[64:67], v[104:107], a[248:251], a[64:67]
    ds_read_b64_tr_b16 v[124:125], v28 offset:1600
    v_mfma_f32_16x16x32_bf16 a[68:71], v[104:107], a[252:255], a[68:71]
    ds_read_b64_tr_b16 v[126:127], v28 offset:1856
    v_mfma_f32_16x16x32_bf16 a[64:67], v[108:111], a[0:3], a[64:67]
    ds_read_b64_tr_b16 v[128:129], v28 offset:11072
    v_accvgpr_read_b32 v144, a56
    v_accvgpr_read_b32 v145, a57
    v_mfma_f32_16x16x32_bf16 a[68:71], v[108:111], a[4:7], a[68:71]
    s_waitcnt lgkmcnt(5)
    ds_read_b64_tr_b16 v[130:131], v28 offset:11328
    v_accvgpr_read_b32 v146, a58
    v_accvgpr_read_b32 v147, a59
    v_mfma_f32_16x16x32_bf16 a[64:67], v[112:115], a[8:11], a[64:67]
    ds_read_b64_tr_b16 v[132:133], v28 offset:20544
    v_accvgpr_read_b32 v148, a60
    v_accvgpr_read_b32 v149, a61
    v_mfma_f32_16x16x32_bf16 a[68:71], v[112:115], a[12:15], a[68:71]
    ds_read_b64_tr_b16 v[134:135], v28 offset:20800
    v_accvgpr_read_b32 v150, a62
    v_accvgpr_read_b32 v151, a63
    v_mfma_f32_16x16x32_bf16 a[64:67], v[116:119], a[16:19], a[64:67]
    ds_read_b64_tr_b16 v[104:105], v26 offset:64
    v_cvt_pk_bf16_f32 v156, v144, v145
    v_cvt_pk_bf16_f32 v157, v146, v147
    v_mfma_f32_16x16x32_bf16 a[68:71], v[116:119], a[20:23], a[68:71]
    s_waitcnt lgkmcnt(5)
    ds_read_b64_tr_b16 v[106:107], v26 offset:320
    v_cvt_pk_bf16_f32 v158, v148, v149
    v_cvt_pk_bf16_f32 v159, v150, v151
    v_mfma_f32_16x16x32_bf16 a[72:75], v[120:123], a[240:243], a[72:75]
    ds_read_b64_tr_b16 v[108:109], v27 offset:57696
    buffer_store_dwordx4 v[156:159], v78, s[52:55], s28 offen sc1
    s_add_u32 s28, s28, 65536
    s_and_b32 s28, s28, 0x7ffff
    v_mfma_f32_16x16x32_bf16 a[76:79], v[120:123], a[244:247], a[76:79]
    ds_read_b64_tr_b16 v[110:111], v27 offset:57952
    v_mfma_f32_16x16x32_bf16 a[72:75], v[124:127], a[248:251], a[72:75]
    ds_read_b64_tr_b16 v[112:113], v28 offset:1632
    v_mfma_f32_16x16x32_bf16 a[76:79], v[124:127], a[252:255], a[76:79]
    s_waitcnt lgkmcnt(5)
    ds_read_b64_tr_b16 v[114:115], v28 offset:1888
    v_mfma_f32_16x16x32_bf16 a[72:75], v[128:131], a[0:3], a[72:75]
    ds_read_b64_tr_b16 v[116:117], v28 offset:11104
    v_accvgpr_read_b32 v136, a64
    v_accvgpr_read_b32 v137, a65
    v_mfma_f32_16x16x32_bf16 a[76:79], v[128:131], a[4:7], a[76:79]
    ds_read_b64_tr_b16 v[118:119], v28 offset:11360
    v_accvgpr_read_b32 v138, a66
    v_accvgpr_read_b32 v139, a67
    v_mfma_f32_16x16x32_bf16 a[72:75], v[132:135], a[8:11], a[72:75]
    ds_read_b64_tr_b16 v[120:121], v28 offset:20576
    v_accvgpr_read_b32 v140, a68
    v_accvgpr_read_b32 v141, a69
    v_mfma_f32_16x16x32_bf16 a[76:79], v[132:135], a[12:15], a[76:79]
    s_waitcnt lgkmcnt(5)
    ds_read_b64_tr_b16 v[122:123], v28 offset:20832
    v_accvgpr_read_b32 v142, a70
    v_accvgpr_read_b32 v143, a71
    v_mfma_f32_16x16x32_bf16 a[72:75], v[104:107], a[16:19], a[72:75]
    ds_read_b64_tr_b16 v[124:125], v26 offset:96
    v_cvt_pk_bf16_f32 v160, v136, v137
    v_cvt_pk_bf16_f32 v161, v138, v139
    v_mfma_f32_16x16x32_bf16 a[76:79], v[104:107], a[20:23], a[76:79]
    ds_read_b64_tr_b16 v[126:127], v26 offset:352
    v_cvt_pk_bf16_f32 v162, v140, v141
    v_cvt_pk_bf16_f32 v163, v142, v143
    v_mfma_f32_16x16x32_bf16 a[80:83], v[108:111], a[240:243], a[80:83]
    ds_read_b64_tr_b16 v[128:129], v27 offset:57728
    buffer_store_dwordx4 v[160:163], v78, s[52:55], s28 offen sc1
    s_add_u32 s28, s28, 65536
    s_and_b32 s28, s28, 0x7ffff
    v_mfma_f32_16x16x32_bf16 a[84:87], v[108:111], a[244:247], a[84:87]
    s_waitcnt lgkmcnt(5)
    ds_read_b64_tr_b16 v[130:131], v27 offset:57984
    v_mfma_f32_16x16x32_bf16 a[80:83], v[112:115], a[248:251], a[80:83]
    ds_read_b64_tr_b16 v[132:133], v28 offset:1664
    v_mfma_f32_16x16x32_bf16 a[84:87], v[112:115], a[252:255], a[84:87]
    ds_read_b64_tr_b16 v[134:135], v28 offset:1920
    v_mfma_f32_16x16x32_bf16 a[80:83], v[116:119], a[0:3], a[80:83]
    ds_read_b64_tr_b16 v[104:105], v28 offset:11136
    v_accvgpr_read_b32 v144, a72
    v_accvgpr_read_b32 v145, a73
    v_mfma_f32_16x16x32_bf16 a[84:87], v[116:119], a[4:7], a[84:87]
    s_waitcnt lgkmcnt(5)
    ds_read_b64_tr_b16 v[106:107], v28 offset:11392
    v_accvgpr_read_b32 v146, a74
    v_accvgpr_read_b32 v147, a75
    v_mfma_f32_16x16x32_bf16 a[80:83], v[120:123], a[8:11], a[80:83]
    ds_read_b64_tr_b16 v[108:109], v28 offset:20608
    v_accvgpr_read_b32 v148, a76
    v_accvgpr_read_b32 v149, a77
    v_mfma_f32_16x16x32_bf16 a[84:87], v[120:123], a[12:15], a[84:87]
    ds_read_b64_tr_b16 v[110:111], v28 offset:20864
    v_accvgpr_read_b32 v150, a78
    v_accvgpr_read_b32 v151, a79
    v_mfma_f32_16x16x32_bf16 a[80:83], v[124:127], a[16:19], a[80:83]
    ds_read_b64_tr_b16 v[112:113], v26 offset:128
    v_cvt_pk_bf16_f32 v164, v144, v145
    v_cvt_pk_bf16_f32 v165, v146, v147
    v_mfma_f32_16x16x32_bf16 a[84:87], v[124:127], a[20:23], a[84:87]
    s_waitcnt lgkmcnt(5)
    ds_read_b64_tr_b16 v[114:115], v26 offset:384
    v_cvt_pk_bf16_f32 v166, v148, v149
    v_cvt_pk_bf16_f32 v167, v150, v151
    v_mfma_f32_16x16x32_bf16 a[88:91], v[128:131], a[240:243], a[88:91]
    ds_read_b64_tr_b16 v[116:117], v27 offset:57760
    buffer_store_dwordx4 v[164:167], v78, s[52:55], s28 offen sc1
    s_add_u32 s28, s28, 65536
    s_and_b32 s28, s28, 0x7ffff
    v_mfma_f32_16x16x32_bf16 a[92:95], v[128:131], a[244:247], a[92:95]
    ds_read_b64_tr_b16 v[118:119], v27 offset:58016
    v_mfma_f32_16x16x32_bf16 a[88:91], v[132:135], a[248:251], a[88:91]
    ds_read_b64_tr_b16 v[120:121], v28 offset:1696
    v_mfma_f32_16x16x32_bf16 a[92:95], v[132:135], a[252:255], a[92:95]
    s_waitcnt lgkmcnt(5)
    ds_read_b64_tr_b16 v[122:123], v28 offset:1952
    v_mfma_f32_16x16x32_bf16 a[88:91], v[104:107], a[0:3], a[88:91]
    ds_read_b64_tr_b16 v[124:125], v28 offset:11168
    v_accvgpr_read_b32 v136, a80
    v_accvgpr_read_b32 v137, a81
    v_mfma_f32_16x16x32_bf16 a[92:95], v[104:107], a[4:7], a[92:95]
    ds_read_b64_tr_b16 v[126:127], v28 offset:11424
    v_accvgpr_read_b32 v138, a82
    v_accvgpr_read_b32 v139, a83
    v_mfma_f32_16x16x32_bf16 a[88:91], v[108:111], a[8:11], a[88:91]
    ds_read_b64_tr_b16 v[128:129], v28 offset:20640
    v_accvgpr_read_b32 v140, a84
    v_accvgpr_read_b32 v141, a85
    v_mfma_f32_16x16x32_bf16 a[92:95], v[108:111], a[12:15], a[92:95]
    s_waitcnt lgkmcnt(5)
    ds_read_b64_tr_b16 v[130:131], v28 offset:20896
    v_accvgpr_read_b32 v142, a86
    v_accvgpr_read_b32 v143, a87
    v_mfma_f32_16x16x32_bf16 a[88:91], v[112:115], a[16:19], a[88:91]
    ds_read_b64_tr_b16 v[132:133], v26 offset:160
    v_cvt_pk_bf16_f32 v168, v136, v137
    v_cvt_pk_bf16_f32 v169, v138, v139
    v_mfma_f32_16x16x32_bf16 a[92:95], v[112:115], a[20:23], a[92:95]
    ds_read_b64_tr_b16 v[134:135], v26 offset:416
    v_cvt_pk_bf16_f32 v170, v140, v141
    v_cvt_pk_bf16_f32 v171, v142, v143
    v_mfma_f32_16x16x32_bf16 a[96:99], v[116:119], a[240:243], a[96:99]
    ds_read_b64_tr_b16 v[104:105], v27 offset:57792
    buffer_store_dwordx4 v[168:171], v78, s[52:55], s28 offen sc1
    s_add_u32 s28, s28, 65536
    s_and_b32 s28, s28, 0x7ffff
    v_mfma_f32_16x16x32_bf16 a[100:103], v[116:119], a[244:247], a[100:103]
    s_waitcnt lgkmcnt(5)
    ds_read_b64_tr_b16 v[106:107], v27 offset:58048
    v_mfma_f32_16x16x32_bf16 a[96:99], v[120:123], a[248:251], a[96:99]
    ds_read_b64_tr_b16 v[108:109], v28 offset:1728
    s_waitcnt vmcnt(4)
    buffer_store_dwordx2 v[24:25], v79, s[52:55], s29 offen sc1
    s_lshl_b32 s29, s4, 16
    s_add_u32 s29, s29, 65536
    s_and_b32 s29, s29, 0x7ffff
    v_mfma_f32_16x16x32_bf16 a[100:103], v[120:123], a[252:255], a[100:103]
    ds_read_b64_tr_b16 v[110:111], v28 offset:1984
    v_mfma_f32_16x16x32_bf16 a[96:99], v[124:127], a[0:3], a[96:99]
    ds_read_b64_tr_b16 v[112:113], v28 offset:11200
    v_accvgpr_read_b32 v144, a88
    v_accvgpr_read_b32 v145, a89
    v_mfma_f32_16x16x32_bf16 a[100:103], v[124:127], a[4:7], a[100:103]
    s_waitcnt lgkmcnt(5)
    ds_read_b64_tr_b16 v[114:115], v28 offset:11456
    v_accvgpr_read_b32 v146, a90
    v_accvgpr_read_b32 v147, a91
    v_mfma_f32_16x16x32_bf16 a[96:99], v[128:131], a[8:11], a[96:99]
    ds_read_b64_tr_b16 v[116:117], v28 offset:20672
    v_accvgpr_read_b32 v148, a92
    v_accvgpr_read_b32 v149, a93
    v_mfma_f32_16x16x32_bf16 a[100:103], v[128:131], a[12:15], a[100:103]
    ds_read_b64_tr_b16 v[118:119], v28 offset:20928
    v_accvgpr_read_b32 v150, a94
    v_accvgpr_read_b32 v151, a95
    v_mfma_f32_16x16x32_bf16 a[96:99], v[132:135], a[16:19], a[96:99]
    ds_read_b64_tr_b16 v[120:121], v26 offset:192
    v_cvt_pk_bf16_f32 v172, v144, v145
    v_cvt_pk_bf16_f32 v173, v146, v147
    v_mfma_f32_16x16x32_bf16 a[100:103], v[132:135], a[20:23], a[100:103]
    s_waitcnt lgkmcnt(5)
    ds_read_b64_tr_b16 v[122:123], v26 offset:448
    v_cvt_pk_bf16_f32 v174, v148, v149
    v_cvt_pk_bf16_f32 v175, v150, v151
    v_mfma_f32_16x16x32_bf16 a[104:107], v[104:107], a[240:243], a[104:107]
    ds_read_b64_tr_b16 v[124:125], v26 offset:9696
    buffer_store_dwordx4 v[172:175], v78, s[52:55], s28 offen sc1
    s_add_u32 s28, s28, 65536
    s_and_b32 s28, s28, 0x7ffff
    v_mfma_f32_16x16x32_bf16 a[108:111], v[104:107], a[244:247], a[108:111]
    ds_read_b64_tr_b16 v[126:127], v26 offset:9952
    v_mfma_f32_16x16x32_bf16 a[104:107], v[108:111], a[248:251], a[104:107]
    ds_read_b64_tr_b16 v[128:129], v26 offset:19168
    s_waitcnt vmcnt(5)
    buffer_store_dwordx2 v[24:25], v79, s[52:55], s29 offen sc1
    s_add_u32 s29, s29, 65536
    s_and_b32 s29, s29, 0x7ffff
    v_mfma_f32_16x16x32_bf16 a[108:111], v[108:111], a[252:255], a[108:111]
    s_waitcnt lgkmcnt(5)
    ds_read_b64_tr_b16 v[130:131], v26 offset:19424
    v_mfma_f32_16x16x32_bf16 a[104:107], v[112:115], a[0:3], a[104:107]
    ds_read_b64_tr_b16 v[132:133], v26 offset:28640
    v_accvgpr_read_b32 v136, a96
    v_accvgpr_read_b32 v137, a97
    v_mfma_f32_16x16x32_bf16 a[108:111], v[112:115], a[4:7], a[108:111]
    ds_read_b64_tr_b16 v[134:135], v26 offset:28896
    v_accvgpr_read_b32 v138, a98
    v_accvgpr_read_b32 v139, a99
    v_mfma_f32_16x16x32_bf16 a[104:107], v[116:119], a[8:11], a[104:107]
    ds_read_b64_tr_b16 v[104:105], v26 offset:38112
    v_accvgpr_read_b32 v140, a100
    v_accvgpr_read_b32 v141, a101
    v_mfma_f32_16x16x32_bf16 a[108:111], v[116:119], a[12:15], a[108:111]
    s_waitcnt lgkmcnt(5)
    ds_read_b64_tr_b16 v[106:107], v26 offset:38368
    v_accvgpr_read_b32 v142, a102
    v_accvgpr_read_b32 v143, a103
    v_mfma_f32_16x16x32_bf16 a[104:107], v[120:123], a[16:19], a[104:107]
    ds_read_b64_tr_b16 v[108:109], v26 offset:47584
    v_cvt_pk_bf16_f32 v176, v136, v137
    v_cvt_pk_bf16_f32 v177, v138, v139
    v_mfma_f32_16x16x32_bf16 a[108:111], v[120:123], a[20:23], a[108:111]
    ds_read_b64_tr_b16 v[110:111], v26 offset:47840
    v_cvt_pk_bf16_f32 v178, v140, v141
    v_cvt_pk_bf16_f32 v179, v142, v143
    v_mfma_f32_16x16x32_bf16 a[112:115], v[124:127], v[96:99], a[112:115]
    ds_read_b64_tr_b16 v[112:113], v26 offset:57056
    buffer_store_dwordx4 v[176:179], v78, s[52:55], s28 offen sc1
    s_add_u32 s28, s28, 65536
    s_and_b32 s28, s28, 0x7ffff
    v_mfma_f32_16x16x32_bf16 a[116:119], v[124:127], v[100:103], a[116:119]
    s_waitcnt lgkmcnt(5)
    ds_read_b64_tr_b16 v[114:115], v26 offset:57312
    v_mfma_f32_16x16x32_bf16 a[112:115], v[128:131], v[232:235], a[112:115]
    ds_read_b64_tr_b16 v[116:117], v27 offset:992
    s_waitcnt vmcnt(6)
    buffer_store_dwordx2 v[24:25], v79, s[52:55], s29 offen sc1
    s_add_u32 s29, s29, 65536
    s_and_b32 s29, s29, 0x7ffff
    v_mfma_f32_16x16x32_bf16 a[116:119], v[128:131], v[236:239], a[116:119]
    ds_read_b64_tr_b16 v[118:119], v27 offset:1248
    v_mfma_f32_16x16x32_bf16 a[112:115], v[132:135], v[240:243], a[112:115]
    ds_read_b64_tr_b16 v[120:121], v27 offset:10464
    v_accvgpr_read_b32 v144, a104
    v_accvgpr_read_b32 v145, a105
    v_mfma_f32_16x16x32_bf16 a[116:119], v[132:135], v[244:247], a[116:119]
    s_waitcnt lgkmcnt(5)
    ds_read_b64_tr_b16 v[122:123], v27 offset:10720
    v_accvgpr_read_b32 v146, a106
    v_accvgpr_read_b32 v147, a107
    v_mfma_f32_16x16x32_bf16 a[112:115], v[104:107], a[144:147], a[112:115]
    ds_read_b64_tr_b16 v[124:125], v27 offset:19936
    v_accvgpr_read_b32 v148, a108
    v_accvgpr_read_b32 v149, a109
    v_mfma_f32_16x16x32_bf16 a[116:119], v[104:107], a[148:151], a[116:119]
    ds_read_b64_tr_b16 v[126:127], v27 offset:20192
    v_accvgpr_read_b32 v150, a110
    v_accvgpr_read_b32 v151, a111
    v_mfma_f32_16x16x32_bf16 a[112:115], v[108:111], a[152:155], a[112:115]
    ds_read_b64_tr_b16 v[128:129], v27 offset:29408
    v_cvt_pk_bf16_f32 v180, v144, v145
    v_cvt_pk_bf16_f32 v181, v146, v147
    v_mfma_f32_16x16x32_bf16 a[116:119], v[108:111], a[156:159], a[116:119]
    s_waitcnt lgkmcnt(5)
    ds_read_b64_tr_b16 v[130:131], v27 offset:29664
    v_cvt_pk_bf16_f32 v182, v148, v149
    v_cvt_pk_bf16_f32 v183, v150, v151
    v_mfma_f32_16x16x32_bf16 a[112:115], v[112:115], a[160:163], a[112:115]
    ds_read_b64_tr_b16 v[132:133], v27 offset:38880
    buffer_store_dwordx4 v[180:183], v78, s[52:55], s28 offen sc1
    s_add_u32 s28, s28, 65536
    s_and_b32 s28, s28, 0x7ffff
    v_mfma_f32_16x16x32_bf16 a[116:119], v[112:115], a[164:167], a[116:119]
    ds_read_b64_tr_b16 v[134:135], v27 offset:39136
    v_mfma_f32_16x16x32_bf16 a[112:115], v[116:119], a[168:171], a[112:115]
    ds_read_b64_tr_b16 v[104:105], v27 offset:48352
    s_waitcnt vmcnt(7)
    buffer_store_dwordx2 v[24:25], v79, s[52:55], s29 offen sc1
    s_add_u32 s29, s29, 65536
    s_and_b32 s29, s29, 0x7ffff
    v_mfma_f32_16x16x32_bf16 a[116:119], v[116:119], a[172:175], a[116:119]
    s_waitcnt lgkmcnt(5)
    ds_read_b64_tr_b16 v[106:107], v27 offset:48608
    v_mfma_f32_16x16x32_bf16 a[112:115], v[120:123], a[176:179], a[112:115]
    ds_read_b64_tr_b16 v[108:109], v27 offset:57824
    v_mfma_f32_16x16x32_bf16 a[116:119], v[120:123], a[180:183], a[116:119]
    ds_read_b64_tr_b16 v[110:111], v27 offset:58080
    v_mfma_f32_16x16x32_bf16 a[112:115], v[124:127], a[184:187], a[112:115]
    ds_read_b64_tr_b16 v[112:113], v28 offset:1760
    v_mfma_f32_16x16x32_bf16 a[116:119], v[124:127], a[188:191], a[116:119]
    s_waitcnt lgkmcnt(5)
    ds_read_b64_tr_b16 v[114:115], v28 offset:2016
    v_mfma_f32_16x16x32_bf16 a[112:115], v[128:131], a[200:203], a[112:115]
    ds_read_b64_tr_b16 v[116:117], v28 offset:11232
    v_mfma_f32_16x16x32_bf16 a[116:119], v[128:131], a[204:207], a[116:119]
    ds_read_b64_tr_b16 v[118:119], v28 offset:11488
    v_mfma_f32_16x16x32_bf16 a[112:115], v[132:135], a[208:211], a[112:115]
    ds_read_b64_tr_b16 v[120:121], v28 offset:20704
    v_mfma_f32_16x16x32_bf16 a[116:119], v[132:135], a[212:215], a[116:119]
    s_waitcnt lgkmcnt(5)
    ds_read_b64_tr_b16 v[122:123], v28 offset:20960
    v_mfma_f32_16x16x32_bf16 a[112:115], v[104:107], a[216:219], a[112:115]
    ds_read_b64_tr_b16 v[124:125], v26 offset:224
    s_waitcnt vmcnt(7)
    buffer_store_dwordx2 v[24:25], v79, s[52:55], s29 offen sc1
    s_add_u32 s29, s29, 65536
    s_and_b32 s29, s29, 0x7ffff
    v_mfma_f32_16x16x32_bf16 a[116:119], v[104:107], a[220:223], a[116:119]
    ds_read_b64_tr_b16 v[126:127], v26 offset:480
    v_mfma_f32_16x16x32_bf16 a[112:115], v[108:111], a[240:243], a[112:115]
    v_mfma_f32_16x16x32_bf16 a[116:119], v[108:111], a[244:247], a[116:119]
    s_waitcnt lgkmcnt(4)
    v_mfma_f32_16x16x32_bf16 a[112:115], v[112:115], a[248:251], a[112:115]
    v_mfma_f32_16x16x32_bf16 a[116:119], v[112:115], a[252:255], a[116:119]
    v_mfma_f32_16x16x32_bf16 a[112:115], v[116:119], a[0:3], a[112:115]
    v_mfma_f32_16x16x32_bf16 a[116:119], v[116:119], a[4:7], a[116:119]
    s_waitcnt lgkmcnt(0)
    v_mfma_f32_16x16x32_bf16 a[112:115], v[120:123], a[8:11], a[112:115]
    v_mfma_f32_16x16x32_bf16 a[116:119], v[120:123], a[12:15], a[116:119]
    v_mfma_f32_16x16x32_bf16 a[112:115], v[124:127], a[16:19], a[112:115]
    s_waitcnt vmcnt(6)
    buffer_store_dwordx2 v[24:25], v79, s[52:55], s29 offen sc1
    s_add_u32 s29, s29, 65536
    s_and_b32 s29, s29, 0x7ffff
    v_mfma_f32_16x16x32_bf16 a[116:119], v[124:127], a[20:23], a[116:119]
    s_waitcnt vmcnt(5)
    buffer_store_dwordx2 v[24:25], v79, s[52:55], s29 offen sc1
    s_add_u32 s29, s29, 65536
    s_and_b32 s29, s29, 0x7ffff
    s_waitcnt vmcnt(4)
    buffer_store_dwordx2 v[24:25], v79, s[52:55], s29 offen sc1
    s_add_u32 s29, s29, 65536
    s_and_b32 s29, s29, 0x7ffff
    s_lshl_b32 s12, s4, 16
    s_lshl_b32 s13, s3, 6
    s_add_u32 s12, s12, s13
    s_lshr_b32 s13, s4, 1
    s_lshl_b32 s13, s13, 6
    s_add_u32 s13, s13, 524224
    v_mov_b32 v29, s12
    v_mov_b32 v30, s13
    v_cmp_gt_u32 vcc, 8, v2
    s_add_u32 s12, s11, 32768
    v_lshlrev_b32 v22, 3, v2
    v_cndmask_b32 v29, v30, v29, vcc
    v_add_u32 v22, s12, v22
    v_add_u32 v22, v29, v22
    s_lshl_b32 s15, 1, s4
    s_xor_b32 s15, s15, 0xffff

    buffer_load_dwordx2 v[20:21], v22, s[52:55], 0 offen offset:0 sc1
    v_accvgpr_read_b32 v208, a112
    v_accvgpr_read_b32 v209, a113
    v_accvgpr_read_b32 v210, a114
    v_accvgpr_read_b32 v211, a115
    v_accvgpr_read_b32 v212, a116
    v_accvgpr_read_b32 v213, a117
    v_accvgpr_read_b32 v214, a118
    v_accvgpr_read_b32 v215, a119
    s_lshl_b32 s23, s4, 16
    s_lshl_b32 s13, s3, 10
    s_add_u32 s23, s23, s13
    s_add_u32 s23, s23, s11
    s_lshr_b32 s13, s4, 1
    s_lshl_b32 s13, s13, 10
    s_and_b32 s24, s4, 1
    s_lshl_b32 s24, s24, 3
    s_add_u32 s24, s24, s13
    s_add_u32 s24, s24, s11
    s_add_u32 s24, s24, 524288
    s_lshl_b32 s25, s4, 12

    s_waitcnt vmcnt(0)
    v_cmp_ne_u64 vcc, v[20:21], v[24:25]
    s_and_b32 s12, vcc_lo, s15
    s_cbranch_scc0 poll_11_ok
    s_mov_b32 s14, 0
poll_11:
    s_sleep 1
    buffer_load_dwordx2 v[20:21], v22, s[52:55], 0 offen offset:0 sc1
    s_add_u32 s14, s14, 1
    s_cmp_gt_u32 s14, 0x8000
    s_cbranch_scc1 poll_11_ok
    s_waitcnt vmcnt(0)
    v_cmp_ne_u64 vcc, v[20:21], v[24:25]
    s_and_b32 s12, vcc_lo, s15
    s_cbranch_scc1 poll_11
poll_11_ok:

    s_add_u32 s25, s25, 4096
    s_and_b32 s25, s25, 0x7fff
    s_add_u32 s12, s25, s23
    buffer_load_dwordx4 v[32:35], v10, s[52:55], s12 offen sc1
    s_add_u32 s25, s25, 4096
    s_and_b32 s25, s25, 0x7fff
    s_add_u32 s12, s25, s23
    buffer_load_dwordx4 v[36:39], v10, s[52:55], s12 offen sc1
    s_add_u32 s25, s25, 4096
    s_and_b32 s25, s25, 0x7fff
    s_add_u32 s12, s25, s23
    buffer_load_dwordx4 v[40:43], v10, s[52:55], s12 offen sc1
    s_add_u32 s25, s25, 4096
    s_and_b32 s25, s25, 0x7fff
    s_add_u32 s12, s25, s23
    buffer_load_dwordx4 v[44:47], v10, s[52:55], s12 offen sc1
    s_add_u32 s25, s25, 4096
    s_and_b32 s25, s25, 0x7fff
    s_add_u32 s12, s25, s23
    buffer_load_dwordx4 v[48:51], v10, s[52:55], s12 offen sc1
    s_add_u32 s25, s25, 4096
    s_and_b32 s25, s25, 0x7fff
    s_add_u32 s12, s25, s23
    buffer_load_dwordx4 v[52:55], v10, s[52:55], s12 offen sc1
    s_add_u32 s25, s25, 4096
    s_and_b32 s25, s25, 0x7fff
    s_add_u32 s12, s25, s23
    buffer_load_dwordx4 v[56:59], v10, s[52:55], s12 offen sc1
    s_lshr_b32 s12, s4, 1
    s_cmp_lg_u32 s12, s3
    s_cbranch_scc1 L_no8a
    buffer_load_dwordx2 v[60:61], v10, s[52:55], s24 offen sc1
    s_add_u32 s24, s24, 4096
    buffer_load_dwordx2 v[62:63], v10, s[52:55], s24 offen sc1
    s_add_u32 s24, s24, 4096
    buffer_load_dwordx2 v[64:65], v10, s[52:55], s24 offen sc1
    s_add_u32 s24, s24, 4096
    buffer_load_dwordx2 v[66:67], v10, s[52:55], s24 offen sc1
    s_add_u32 s24, s24, 4096
    buffer_load_dwordx2 v[68:69], v10, s[52:55], s24 offen sc1
    s_add_u32 s24, s24, 4096
    buffer_load_dwordx2 v[70:71], v10, s[52:55], s24 offen sc1
    s_add_u32 s24, s24, 4096
    buffer_load_dwordx2 v[72:73], v10, s[52:55], s24 offen sc1
    s_add_u32 s24, s24, 4096
    buffer_load_dwordx2 v[74:75], v10, s[52:55], s24 offen sc1
    s_add_u32 s24, s24, 4096
L_no8a:
    s_waitcnt vmcnt(6)
    v_lshlrev_b32 v29, 16, v32
    v_and_b32 v30, 0xffff0000, v32
    v_add_f32 v208, v208, v29
    v_add_f32 v209, v209, v30

    v_lshlrev_b32 v29, 16, v33
    v_and_b32 v30, 0xffff0000, v33
    v_add_f32 v210, v210, v29
    v_add_f32 v211, v211, v30

    v_lshlrev_b32 v29, 16, v34
    v_and_b32 v30, 0xffff0000, v34
    v_add_f32 v212, v212, v29
    v_add_f32 v213, v213, v30

    v_lshlrev_b32 v29, 16, v35
    v_and_b32 v30, 0xffff0000, v35
    v_add_f32 v214, v214, v29
    v_add_f32 v215, v215, v30

    s_waitcnt vmcnt(5)
    v_lshlrev_b32 v29, 16, v36
    v_and_b32 v30, 0xffff0000, v36
    v_add_f32 v208, v208, v29
    v_add_f32 v209, v209, v30

    v_lshlrev_b32 v29, 16, v37
    v_and_b32 v30, 0xffff0000, v37
    v_add_f32 v210, v210, v29
    v_add_f32 v211, v211, v30

    v_lshlrev_b32 v29, 16, v38
    v_and_b32 v30, 0xffff0000, v38
    v_add_f32 v212, v212, v29
    v_add_f32 v213, v213, v30

    v_lshlrev_b32 v29, 16, v39
    v_and_b32 v30, 0xffff0000, v39
    v_add_f32 v214, v214, v29
    v_add_f32 v215, v215, v30

    s_waitcnt vmcnt(4)
    v_lshlrev_b32 v29, 16, v40
    v_and_b32 v30, 0xffff0000, v40
    v_add_f32 v208, v208, v29
    v_add_f32 v209, v209, v30

    v_lshlrev_b32 v29, 16, v41
    v_and_b32 v30, 0xffff0000, v41
    v_add_f32 v210, v210, v29
    v_add_f32 v211, v211, v30

    v_lshlrev_b32 v29, 16, v42
    v_and_b32 v30, 0xffff0000, v42
    v_add_f32 v212, v212, v29
    v_add_f32 v213, v213, v30

    v_lshlrev_b32 v29, 16, v43
    v_and_b32 v30, 0xffff0000, v43
    v_add_f32 v214, v214, v29
    v_add_f32 v215, v215, v30

    s_waitcnt vmcnt(3)
    v_lshlrev_b32 v29, 16, v44
    v_and_b32 v30, 0xffff0000, v44
    v_add_f32 v208, v208, v29
    v_add_f32 v209, v209, v30

    v_lshlrev_b32 v29, 16, v45
    v_and_b32 v30, 0xffff0000, v45
    v_add_f32 v210, v210, v29
    v_add_f32 v211, v211, v30

    v_lshlrev_b32 v29, 16, v46
    v_and_b32 v30, 0xffff0000, v46
    v_add_f32 v212, v212, v29
    v_add_f32 v213, v213, v30

    v_lshlrev_b32 v29, 16, v47
    v_and_b32 v30, 0xffff0000, v47
    v_add_f32 v214, v214, v29
    v_add_f32 v215, v215, v30

    s_waitcnt vmcnt(2)
    v_lshlrev_b32 v29, 16, v48
    v_and_b32 v30, 0xffff0000, v48
    v_add_f32 v208, v208, v29
    v_add_f32 v209, v209, v30

    v_lshlrev_b32 v29, 16, v49
    v_and_b32 v30, 0xffff0000, v49
    v_add_f32 v210, v210, v29
    v_add_f32 v211, v211, v30

    v_lshlrev_b32 v29, 16, v50
    v_and_b32 v30, 0xffff0000, v50
    v_add_f32 v212, v212, v29
    v_add_f32 v213, v213, v30

    v_lshlrev_b32 v29, 16, v51
    v_and_b32 v30, 0xffff0000, v51
    v_add_f32 v214, v214, v29
    v_add_f32 v215, v215, v30

    s_waitcnt vmcnt(1)
    v_lshlrev_b32 v29, 16, v52
    v_and_b32 v30, 0xffff0000, v52
    v_add_f32 v208, v208, v29
    v_add_f32 v209, v209, v30

    v_lshlrev_b32 v29, 16, v53
    v_and_b32 v30, 0xffff0000, v53
    v_add_f32 v210, v210, v29
    v_add_f32 v211, v211, v30

    v_lshlrev_b32 v29, 16, v54
    v_and_b32 v30, 0xffff0000, v54
    v_add_f32 v212, v212, v29
    v_add_f32 v213, v213, v30

    v_lshlrev_b32 v29, 16, v55
    v_and_b32 v30, 0xffff0000, v55
    v_add_f32 v214, v214, v29
    v_add_f32 v215, v215, v30

    s_waitcnt vmcnt(0)
    v_lshlrev_b32 v29, 16, v56
    v_and_b32 v30, 0xffff0000, v56
    v_add_f32 v208, v208, v29
    v_add_f32 v209, v209, v30

    v_lshlrev_b32 v29, 16, v57
    v_and_b32 v30, 0xffff0000, v57
    v_add_f32 v210, v210, v29
    v_add_f32 v211, v211, v30

    v_lshlrev_b32 v29, 16, v58
    v_and_b32 v30, 0xffff0000, v58
    v_add_f32 v212, v212, v29
    v_add_f32 v213, v213, v30

    v_lshlrev_b32 v29, 16, v59
    v_and_b32 v30, 0xffff0000, v59
    v_add_f32 v214, v214, v29
    v_add_f32 v215, v215, v30

    v_cvt_pk_bf16_f32 v209, v208, v209
    v_lshlrev_b32 v208, 16, v209
    v_and_b32 v209, 0xffff0000, v209
    v_lshlrev_b32 v29, 16, v224
    v_and_b32 v30, 0xffff0000, v224
    v_add_f32 v208, v208, v29
    v_add_f32 v209, v209, v30
    v_cvt_pk_bf16_f32 v216, v208, v209

    v_cvt_pk_bf16_f32 v211, v210, v211
    v_lshlrev_b32 v210, 16, v211
    v_and_b32 v211, 0xffff0000, v211
    v_lshlrev_b32 v29, 16, v225
    v_and_b32 v30, 0xffff0000, v225
    v_add_f32 v210, v210, v29
    v_add_f32 v211, v211, v30
    v_cvt_pk_bf16_f32 v217, v210, v211

    v_cvt_pk_bf16_f32 v213, v212, v213
    v_lshlrev_b32 v212, 16, v213
    v_and_b32 v213, 0xffff0000, v213
    v_lshlrev_b32 v29, 16, v226
    v_and_b32 v30, 0xffff0000, v226
    v_add_f32 v212, v212, v29
    v_add_f32 v213, v213, v30
    v_cvt_pk_bf16_f32 v218, v212, v213

    v_cvt_pk_bf16_f32 v215, v214, v215
    v_lshlrev_b32 v214, 16, v215
    v_and_b32 v215, 0xffff0000, v215
    v_lshlrev_b32 v29, 16, v227
    v_and_b32 v30, 0xffff0000, v227
    v_add_f32 v214, v214, v29
    v_add_f32 v215, v215, v30
    v_cvt_pk_bf16_f32 v219, v214, v215

    s_mul_i32 s12, s19, 18432
    s_lshl_b32 s13, s8, 8
    s_add_u32 s12, s12, s13
    s_lshl_b32 s13, s4, 5
    s_add_u32 s12, s12, s13
    s_add_u32 s13, s12, 18432
    buffer_store_dwordx2 v[216:217], v77, s[56:59], s12 offen nt
    buffer_store_dwordx2 v[218:219], v77, s[56:59], s13 offen nt
    s_lshr_b32 s12, s4, 1
    s_cmp_lg_u32 s12, s3
    s_cbranch_scc1 L_no8

    v_lshlrev_b32 v208, 16, v60
    v_and_b32 v209, 0xffff0000, v60
    v_lshlrev_b32 v210, 16, v61
    v_and_b32 v211, 0xffff0000, v61
    v_lshlrev_b32 v29, 16, v62
    v_and_b32 v30, 0xffff0000, v62
    v_add_f32 v208, v208, v29
    v_add_f32 v209, v209, v30

    v_lshlrev_b32 v29, 16, v63
    v_and_b32 v30, 0xffff0000, v63
    v_add_f32 v210, v210, v29
    v_add_f32 v211, v211, v30

    v_lshlrev_b32 v29, 16, v64
    v_and_b32 v30, 0xffff0000, v64
    v_add_f32 v208, v208, v29
    v_add_f32 v209, v209, v30

    v_lshlrev_b32 v29, 16, v65
    v_and_b32 v30, 0xffff0000, v65
    v_add_f32 v210, v210, v29
    v_add_f32 v211, v211, v30

    v_lshlrev_b32 v29, 16, v66
    v_and_b32 v30, 0xffff0000, v66
    v_add_f32 v208, v208, v29
    v_add_f32 v209, v209, v30

    v_lshlrev_b32 v29, 16, v67
    v_and_b32 v30, 0xffff0000, v67
    v_add_f32 v210, v210, v29
    v_add_f32 v211, v211, v30

    v_lshlrev_b32 v29, 16, v68
    v_and_b32 v30, 0xffff0000, v68
    v_add_f32 v208, v208, v29
    v_add_f32 v209, v209, v30

    v_lshlrev_b32 v29, 16, v69
    v_and_b32 v30, 0xffff0000, v69
    v_add_f32 v210, v210, v29
    v_add_f32 v211, v211, v30

    v_lshlrev_b32 v29, 16, v70
    v_and_b32 v30, 0xffff0000, v70
    v_add_f32 v208, v208, v29
    v_add_f32 v209, v209, v30

    v_lshlrev_b32 v29, 16, v71
    v_and_b32 v30, 0xffff0000, v71
    v_add_f32 v210, v210, v29
    v_add_f32 v211, v211, v30

    v_lshlrev_b32 v29, 16, v72
    v_and_b32 v30, 0xffff0000, v72
    v_add_f32 v208, v208, v29
    v_add_f32 v209, v209, v30

    v_lshlrev_b32 v29, 16, v73
    v_and_b32 v30, 0xffff0000, v73
    v_add_f32 v210, v210, v29
    v_add_f32 v211, v211, v30

    v_lshlrev_b32 v29, 16, v74
    v_and_b32 v30, 0xffff0000, v74
    v_add_f32 v208, v208, v29
    v_add_f32 v209, v209, v30

    v_lshlrev_b32 v29, 16, v75
    v_and_b32 v30, 0xffff0000, v75
    v_add_f32 v210, v210, v29
    v_add_f32 v211, v211, v30

    v_cvt_pk_bf16_f32 v209, v208, v209
    v_lshlrev_b32 v208, 16, v209
    v_and_b32 v209, 0xffff0000, v209
    v_lshlrev_b32 v29, 16, v228
    v_and_b32 v30, 0xffff0000, v228
    v_add_f32 v208, v208, v29
    v_add_f32 v209, v209, v30
    v_cvt_pk_bf16_f32 v220, v208, v209

    v_cvt_pk_bf16_f32 v211, v210, v211
    v_lshlrev_b32 v210, 16, v211
    v_and_b32 v211, 0xffff0000, v211
    v_lshlrev_b32 v29, 16, v229
    v_and_b32 v30, 0xffff0000, v229
    v_add_f32 v210, v210, v29
    v_add_f32 v211, v211, v30
    v_cvt_pk_bf16_f32 v221, v210, v211

    s_lshl_b32 s12, s9, 3
    s_add_u32 s12, s12, s4
    s_mul_i32 s12, s12, 18432
    s_lshl_b32 s13, s8, 5
    s_add_u32 s12, s12, s13
    s_add_u32 s12, s12, 1024
    buffer_store_dwordx2 v[220:221], v77, s[56:59], s12 offen nt
L_no8:

L_end:
    s_endpgm
.section .rodata,"a"
.p2align 6
.amdhsa_kernel standalone__mixer_s_mlp__sampling_kernel
  .amdhsa_next_free_vgpr 512
  .amdhsa_next_free_sgpr 102
  .amdhsa_accum_offset 256
  .amdhsa_group_segment_fixed_size 0
  .amdhsa_kernarg_size 64
  .amdhsa_user_sgpr_count 2
  .amdhsa_user_sgpr_kernarg_segment_ptr 1
  .amdhsa_system_sgpr_workgroup_id_x 1
.end_amdhsa_kernel
.text
```
